```python
import torch

def _softmax(x, axis=-1):
    return torch.softmax(x, dim=axis)
def _gelu(x):
    return torch.nn.functional.gelu(x, approximate="tanh")
def _silu(x):
    return torch.nn.functional.silu(x)
def _sigmoid(x):
    return torch.sigmoid(x)
def _layernorm(x, axis=-1, eps=1e-5):
    m = x.mean(dim=axis, keepdim=True)
    v = x.var(dim=axis, keepdim=True, unbiased=False)
    return (x - m) / torch.sqrt(v + eps)
def _scatter_add(tgt, idx, src, axis=0):
    return tgt.clone().index_add_(axis, idx, src)
def _segment_sum(src, seg, n):
    out = torch.zeros((n,) + src.shape[1:], dtype=src.dtype)
    return out.index_add_(0, seg, src)
def _pad(x, pw):
    flat = tuple(v for pair in reversed(pw) for v in pair)
    return torch.nn.functional.pad(x, flat)

kernel_name = 'gated_mix__mha_block__dense_activation_relu__prompt'

def setup_inputs():

    _w = (lambda a: (lambda t: t.to(torch.bfloat16) if t.is_floating_point() else t)(torch.as_tensor(a)))
    def _A_setup():
        B, S, D, H = 1, 2048, 512, 32
        return {
            "x": _w((lambda *s: torch.randn(*s, dtype=torch.bfloat16) * 0.05)(B, S, D)),
            "wqkv": _w((lambda *s: torch.randn(*s, dtype=torch.bfloat16) * 0.8)(D, 3 * D)),
            "wo": _w((lambda *s: torch.randn(*s, dtype=torch.bfloat16) * 0.2)(D, D)),
        }
    _A_in = _A_setup()

    def _B_setup():
        B, S, D, Dff = 1, 2048, 512, 1792
        return {
            "x": _w((lambda *s: torch.randn(*s, dtype=torch.bfloat16) * 0.05)(B, S, D)),
            "w1": _w((lambda *s: torch.randn(*s, dtype=torch.bfloat16) * 0.05)(D, Dff)),
            "w2": _w((lambda *s: torch.randn(*s, dtype=torch.bfloat16) * 0.05)(Dff, D)),
        }
    _B_in = _B_setup()

    return {
        "A_x": _A_in["x"],
        "A_wqkv": _A_in["wqkv"],
        "A_wo": _A_in["wo"],
        "B_x": _B_in["x"],
        "B_w1": _B_in["w1"],
        "B_w2": _B_in["w2"],
        "gate_w": _w((lambda *s: torch.randn(*s, dtype=torch.bfloat16) * 0.05)(512) * 16.0),
    }

def reference(A_x, A_wqkv, A_wo, B_x, B_w1, B_w2, gate_w):
    def _A_ref(x, wqkv, wo):
        B, S, D = x.shape
        H = 32
        Dh = D // H
        qkv = (lambda x, *d: x.permute(*d))((x @ wqkv).reshape(B, S, 3, H, Dh), 2, 0, 3, 1, 4)
        q, k, v = qkv[0], qkv[1], qkv[2]
        scores = torch.einsum("bhqd,bhkd->bhqk", q, k) * (Dh ** -0.5)
        p = _softmax(scores, axis=-1)
        o = torch.einsum("bhqk,bhkd->bhqd", p, v)
        return (lambda x, *d: x.permute(*d))(o, 0, 2, 1, 3).reshape(B, S, D) @ wo

    def _B_ref(x, w1, w2):
        h = torch.einsum("bsd,df->bsf", x, w1)
        zero = torch.zeros_like(h)
        h = torch.maximum(h, zero)
        return torch.einsum("bsf,fd->bsd", h, w2)

    x = A_x
    g = _sigmoid((x * gate_w).sum(-1, keepdims=True))
    a = _A_ref(x, A_wqkv, A_wo)
    b = _B_ref(x, B_w1, B_w2)
    return g * a + (1 - g) * b
```

```asm
; @launch grid=(256,1,1) block=(768,1,1) lds=163840
.amdgcn_target "amdgcn-amd-amdhsa--gfx950"
.text
.globl gated_mix__mha_block__dense_activation_relu__prompt_kernel
.p2align 8
.type gated_mix__mha_block__dense_activation_relu__prompt_kernel,@function
gated_mix__mha_block__dense_activation_relu__prompt_kernel:
    s_cmp_ge_u32 s2, 256
    s_cbranch_scc1 L_end
    s_load_dwordx16 s[8:23], s[0:1], 0
    s_load_dwordx4 s[24:27], s[0:1], 64
    v_lshrrev_b32 v2, 6, v0
    v_and_b32 v1, 63, v0
    s_mov_b32 s83, 0
    v_readfirstlane_b32 s40, v2
    s_and_b32 s3, s2, 7
    s_lshr_b32 s4, s2, 3
    s_and_b32 s43, s4, 3
    s_lshl_b32 s5, s3, 2
    s_add_u32 s41, s43, s5
    s_lshr_b32 s42, s4, 2
    s_and_b32 s72, s41, 7
    s_lshr_b32 s5, s3, 1
    s_lshl_b32 s5, s5, 3
    s_and_b32 s6, s4, 7
    s_add_u32 s86, s5, s6
    s_and_b32 s5, s3, 1
    s_lshl_b32 s87, s5, 2
    s_lshr_b32 s7, s4, 3
    s_add_u32 s87, s87, s7
    s_lshl_b32 s7, s7, 1
    s_add_u32 s87, s7, s5
    s_add_u32 s49, s6, s7
    s_add_u32 s49, s49, s5
    s_and_b32 s49, s49, 7
    v_lshlrev_b32 v2, 4, v1
    s_getpc_b64 s[74:75]
L_pc:
    s_mul_i32 s5, s4, 12
    s_add_u32 s5, s5, s40
    s_lshl_b32 s5, s5, 7
    s_min_u32 s5, s5, L_end-L_pc-64
    s_and_b32 s74, s74, -128
    v_lshl_add_u32 v3, v1, 6, s5
    s_mov_b64 exec, 3
    global_load_dword v63, v3, s[74:75]
    s_mov_b64 exec, -1
    s_cmp_ge_u32 s40, 8
    s_cbranch_scc1 L_aux
    v_lshrrev_b32 v3, 3, v1
    v_mul_u32_u24 v4, 3072, v3
    v_bfe_u32 v5, v1, 4, 1
    v_lshlrev_b32 v5, 2, v5
    v_and_b32 v6, 7, v1
    v_xor_b32 v6, v6, v5
    v_lshl_add_u32 v14, v6, 4, v4
    s_mul_i32 s52, s40, 24576
    s_lshl_b32 s5, s87, 7
    s_add_u32 s52, s52, s5
    s_lshl_b32 s53, s40, 10
    s_waitcnt lgkmcnt(0)
    s_mov_b32 s32, s10
    s_and_b32 s33, s11, 0xffff
    s_mov_b32 s34, 0x180000
    s_mov_b32 s35, 0x20000
    s_add_u32 s5, s49, 0
    s_and_b32 s5, s5, 7
    s_mul_i32 s50, s5, 196608
    s_add_u32 s50, s50, s52
    s_add_u32 m0, s53, 139264
    s_add_u32 s51, s50, 0
    buffer_load_dwordx4 v14, s[32:35], s51 offen lds
    s_add_u32 m0, s53, 147456
    s_add_u32 s51, s50, 1024
    buffer_load_dwordx4 v14, s[32:35], s51 offen lds
    s_add_u32 m0, s53, 155648
    s_add_u32 s51, s50, 2048
    buffer_load_dwordx4 v14, s[32:35], s51 offen lds
    s_add_u32 s5, s49, 1
    s_and_b32 s5, s5, 7
    s_mul_i32 s50, s5, 196608
    s_add_u32 s50, s50, s52
    s_add_u32 m0, s53, 114688
    s_add_u32 s51, s50, 0
    buffer_load_dwordx4 v14, s[32:35], s51 offen lds
    s_add_u32 m0, s53, 122880
    s_add_u32 s51, s50, 1024
    buffer_load_dwordx4 v14, s[32:35], s51 offen lds
    s_add_u32 m0, s53, 131072
    s_add_u32 s51, s50, 2048
    buffer_load_dwordx4 v14, s[32:35], s51 offen lds
    s_load_dword s84, s[26:27], 0
    s_mov_b32 s36, s26
    s_and_b32 s37, s27, 0xffff
    s_mov_b32 s38, 0x2000000
    s_mov_b32 s39, 0x20000
    s_branch L_att1
L_aux:
    s_setprio 3
    s_sub_u32 s43, s40, 8
    v_lshrrev_b32 v3, 3, v1
    v_lshlrev_b32 v3, 10, v3
    v_and_b32 v4, 7, v1
    v_lshrrev_b32 v5, 4, v1
    v_xor_b32 v4, v4, v5
    v_lshl_add_u32 v14, v4, 4, v3
    v_xor_b32 v4, 4, v4
    v_lshl_add_u32 v15, v4, 4, v3
    v_add_u32 v15, 8192, v15
    s_lshl_b32 s78, s86, 16
    s_lshl_b32 s5, s43, 14
    s_add_u32 s78, s78, s5
    s_lshl_b32 s79, s43, 11
    s_waitcnt lgkmcnt(0)
    s_mov_b32 s28, s8
    s_and_b32 s29, s9, 0xffff
    s_mov_b32 s30, 0x200000
    s_mov_b32 s31, 0x20000
    s_add_u32 s5, s49, 0
    s_and_b32 s5, s5, 7
    s_lshl_b32 s5, s5, 7
    s_add_u32 m0, s79, 49152
    s_add_u32 s50, s5, s78
    buffer_load_dwordx4 v14, s[28:31], s50 offen lds
    s_add_u32 m0, s79, 50176
    s_nop 0
    buffer_load_dwordx4 v15, s[28:31], s50 offen lds
    s_add_u32 s5, s49, 1
    s_and_b32 s5, s5, 7
    s_lshl_b32 s5, s5, 7
    s_add_u32 m0, s79, 57344
    s_add_u32 s50, s5, s78
    buffer_load_dwordx4 v14, s[28:31], s50 offen lds
    s_add_u32 m0, s79, 58368
    s_nop 0
    buffer_load_dwordx4 v15, s[28:31], s50 offen lds
    s_add_u32 s5, s49, 2
    s_and_b32 s5, s5, 7
    s_lshl_b32 s5, s5, 7
    s_add_u32 m0, s79, 65536
    s_add_u32 s50, s5, s78
    buffer_load_dwordx4 v14, s[28:31], s50 offen lds
    s_add_u32 m0, s79, 66560
    s_nop 0
    buffer_load_dwordx4 v15, s[28:31], s50 offen lds
    s_add_u32 s5, s49, 3
    s_and_b32 s5, s5, 7
    s_lshl_b32 s5, s5, 7
    s_add_u32 m0, s79, 73728
    s_add_u32 s50, s5, s78
    buffer_load_dwordx4 v14, s[28:31], s50 offen lds
    s_add_u32 m0, s79, 74752
    s_nop 0
    buffer_load_dwordx4 v15, s[28:31], s50 offen lds
    s_load_dword s84, s[26:27], 0
    s_mov_b32 s36, s26
    s_and_b32 s37, s27, 0xffff
    s_mov_b32 s38, 0x2000000
    s_mov_b32 s39, 0x20000
    s_branch L_aux1
L_att1:
    s_waitcnt lgkmcnt(0)
    s_mul_i32 s82, s84, 0x9e3779b1
    s_add_u32 s82, s82, 0x7f4a7c15
    v_and_b32 v3, 31, v1
    v_lshrrev_b32 v4, 5, v1
    v_bfe_u32 v5, v1, 1, 3
    v_xor_b32 v5, v5, v4
    v_lshlrev_b32 v3, 7, v3
    s_and_b32 s5, s40, 1
    s_lshl_b32 s5, s5, 12
    s_add_u32 s5, s5, 49152
    v_add_u32 v3, s5, v3
    v_xor_b32 v7, 0, v5
    v_lshl_add_u32 v8, v7, 4, v3
    v_xor_b32 v7, 2, v5
    v_lshl_add_u32 v9, v7, 4, v3
    v_xor_b32 v7, 4, v5
    v_lshl_add_u32 v10, v7, 4, v3
    v_xor_b32 v7, 6, v5
    v_lshl_add_u32 v11, v7, 4, v3
    v_bfe_u32 v7, v1, 2, 2
    v_lshl_add_u32 v7, v4, 3, v7
    v_lshlrev_b32 v12, 7, v7
    v_bfe_u32 v5, v1, 4, 1
    v_bfe_u32 v6, v1, 1, 1
    v_lshl_add_u32 v6, v5, 1, v6
    v_bfe_u32 v5, v1, 3, 1
    s_lshr_b32 s5, s40, 1
    s_and_b32 s5, s5, 1
    v_xor_b32 v5, s5, v5
    v_lshl_add_u32 v6, v5, 2, v6
    v_lshl_add_u32 v12, v6, 4, v12
    v_and_b32 v5, 1, v1
    v_lshl_add_u32 v12, v5, 3, v12
    s_lshr_b32 s5, s40, 2
    s_lshl_b32 s5, s5, 13
    v_add_u32 v12, s5, v12
    v_add_u32 v62, 114688, v12
    v_mov_b32 v13, 157696
    s_waitcnt vmcnt(3)
    s_barrier
    s_add_u32 s5, s49, 2
    s_and_b32 s5, s5, 7
    s_mul_i32 s50, s5, 196608
    s_add_u32 s50, s50, s52
    s_add_u32 m0, s53, 24576
    s_add_u32 s51, s50, 0
    buffer_load_dwordx4 v14, s[32:35], s51 offen lds
    s_add_u32 m0, s53, 32768
    s_add_u32 s51, s50, 1024
    buffer_load_dwordx4 v14, s[32:35], s51 offen lds
    s_add_u32 m0, s53, 40960
    s_add_u32 s51, s50, 2048
    buffer_load_dwordx4 v14, s[32:35], s51 offen lds
    s_add_u32 s5, s49, 3
    s_and_b32 s5, s5, 7
    s_mul_i32 s50, s5, 196608
    s_add_u32 s50, s50, s52
    s_add_u32 m0, s53, 0
    s_add_u32 s51, s50, 0
    buffer_load_dwordx4 v14, s[32:35], s51 offen lds
    s_add_u32 m0, s53, 8192
    s_add_u32 s51, s50, 1024
    buffer_load_dwordx4 v14, s[32:35], s51 offen lds
    s_add_u32 m0, s53, 16384
    s_add_u32 s51, s50, 2048
    buffer_load_dwordx4 v14, s[32:35], s51 offen lds
    ds_read_b128 v[80:83], v8 offset:0
    ds_read_b64_tr_b16 v[96:97], v62 offset:24576
    ds_read_b64_tr_b16 v[98:99], v62 offset:25088
    ds_read_b128 v[84:87], v9 offset:0
    ds_read_b64_tr_b16 v[100:101], v62 offset:26624
    ds_read_b64_tr_b16 v[102:103], v62 offset:27136
    ds_read_b128 v[88:91], v10 offset:0
    ds_read_b64_tr_b16 v[104:105], v62 offset:28672
    ds_read_b64_tr_b16 v[106:107], v62 offset:29184
    ds_read_b128 v[92:95], v11 offset:0
    ds_read_b64_tr_b16 v[108:109], v62 offset:30720
    ds_read_b64_tr_b16 v[110:111], v62 offset:31232
    s_waitcnt lgkmcnt(0)
    s_waitcnt vmcnt(6)
    s_barrier
    s_add_u32 s5, s49, 4
    s_and_b32 s5, s5, 7
    s_mul_i32 s50, s5, 196608
    s_add_u32 s50, s50, s52
    s_add_u32 m0, s53, 139264
    s_add_u32 s51, s50, 0
    buffer_load_dwordx4 v14, s[32:35], s51 offen lds
    s_add_u32 m0, s53, 147456
    s_add_u32 s51, s50, 1024
    buffer_load_dwordx4 v14, s[32:35], s51 offen lds
    s_add_u32 m0, s53, 155648
    s_add_u32 s51, s50, 2048
    buffer_load_dwordx4 v14, s[32:35], s51 offen lds
    ds_read_b128 v[112:115], v8 offset:8192
    ds_read_b64_tr_b16 v[128:129], v62 offset:0
    ds_read_b64_tr_b16 v[130:131], v62 offset:512
    ds_read_b128 v[116:119], v9 offset:8192
    ds_read_b64_tr_b16 v[132:133], v62 offset:2048
    ds_read_b64_tr_b16 v[134:135], v62 offset:2560
    ds_read_b128 v[120:123], v10 offset:8192
    ds_read_b64_tr_b16 v[136:137], v62 offset:4096
    ds_read_b64_tr_b16 v[138:139], v62 offset:4608
    ds_read_b128 v[124:127], v11 offset:8192
    ds_read_b64_tr_b16 v[140:141], v62 offset:6144
    ds_read_b64_tr_b16 v[142:143], v62 offset:6656
    v_mfma_f32_32x32x16_bf16 v[64:79], v[96:99], v[80:83], 0
    v_mfma_f32_32x32x16_bf16 v[64:79], v[100:103], v[84:87], v[64:79]
    v_mfma_f32_32x32x16_bf16 v[64:79], v[104:107], v[88:91], v[64:79]
    v_mfma_f32_32x32x16_bf16 v[64:79], v[108:111], v[92:95], v[64:79]
    s_waitcnt lgkmcnt(0)
    s_waitcnt vmcnt(6)
    s_barrier
    s_add_u32 s5, s49, 5
    s_and_b32 s5, s5, 7
    s_mul_i32 s50, s5, 196608
    s_add_u32 s50, s50, s52
    s_add_u32 m0, s53, 114688
    s_add_u32 s51, s50, 0
    buffer_load_dwordx4 v14, s[32:35], s51 offen lds
    s_add_u32 m0, s53, 122880
    s_add_u32 s51, s50, 1024
    buffer_load_dwordx4 v14, s[32:35], s51 offen lds
    s_add_u32 m0, s53, 131072
    s_add_u32 s51, s50, 2048
    buffer_load_dwordx4 v14, s[32:35], s51 offen lds
    ds_read_b128 v[80:83], v8 offset:16384
    ds_read_b64_tr_b16 v[96:97], v12 offset:24576
    ds_read_b64_tr_b16 v[98:99], v12 offset:25088
    ds_read_b128 v[84:87], v9 offset:16384
    ds_read_b64_tr_b16 v[100:101], v12 offset:26624
    ds_read_b64_tr_b16 v[102:103], v12 offset:27136
    ds_read_b128 v[88:91], v10 offset:16384
    ds_read_b64_tr_b16 v[104:105], v12 offset:28672
    ds_read_b64_tr_b16 v[106:107], v12 offset:29184
    ds_read_b128 v[92:95], v11 offset:16384
    ds_read_b64_tr_b16 v[108:109], v12 offset:30720
    ds_read_b64_tr_b16 v[110:111], v12 offset:31232
    v_mfma_f32_32x32x16_bf16 v[64:79], v[128:131], v[112:115], v[64:79]
    v_mfma_f32_32x32x16_bf16 v[64:79], v[132:135], v[116:119], v[64:79]
    v_mfma_f32_32x32x16_bf16 v[64:79], v[136:139], v[120:123], v[64:79]
    v_mfma_f32_32x32x16_bf16 v[64:79], v[140:143], v[124:127], v[64:79]
    s_waitcnt lgkmcnt(0)
    s_waitcnt vmcnt(6)
    s_barrier
    s_add_u32 s5, s49, 6
    s_and_b32 s5, s5, 7
    s_mul_i32 s50, s5, 196608
    s_add_u32 s50, s50, s52
    s_add_u32 m0, s53, 24576
    s_add_u32 s51, s50, 0
    buffer_load_dwordx4 v14, s[32:35], s51 offen lds
    s_add_u32 m0, s53, 32768
    s_add_u32 s51, s50, 1024
    buffer_load_dwordx4 v14, s[32:35], s51 offen lds
    s_add_u32 m0, s53, 40960
    s_add_u32 s51, s50, 2048
    buffer_load_dwordx4 v14, s[32:35], s51 offen lds
    ds_read_b128 v[112:115], v8 offset:24576
    ds_read_b64_tr_b16 v[128:129], v12 offset:0
    ds_read_b64_tr_b16 v[130:131], v12 offset:512
    ds_read_b128 v[116:119], v9 offset:24576
    ds_read_b64_tr_b16 v[132:133], v12 offset:2048
    ds_read_b64_tr_b16 v[134:135], v12 offset:2560
    ds_read_b128 v[120:123], v10 offset:24576
    ds_read_b64_tr_b16 v[136:137], v12 offset:4096
    ds_read_b64_tr_b16 v[138:139], v12 offset:4608
    ds_read_b128 v[124:127], v11 offset:24576
    ds_read_b64_tr_b16 v[140:141], v12 offset:6144
    ds_read_b64_tr_b16 v[142:143], v12 offset:6656
    v_mfma_f32_32x32x16_bf16 v[64:79], v[96:99], v[80:83], v[64:79]
    v_mfma_f32_32x32x16_bf16 v[64:79], v[100:103], v[84:87], v[64:79]
    v_mfma_f32_32x32x16_bf16 v[64:79], v[104:107], v[88:91], v[64:79]
    v_mfma_f32_32x32x16_bf16 v[64:79], v[108:111], v[92:95], v[64:79]
    s_waitcnt lgkmcnt(0)
    s_waitcnt vmcnt(6)
    s_barrier
    s_add_u32 s5, s49, 7
    s_and_b32 s5, s5, 7
    s_mul_i32 s50, s5, 196608
    s_add_u32 s50, s50, s52
    s_add_u32 m0, s53, 0
    s_add_u32 s51, s50, 0
    buffer_load_dwordx4 v14, s[32:35], s51 offen lds
    s_add_u32 m0, s53, 8192
    s_add_u32 s51, s50, 1024
    buffer_load_dwordx4 v14, s[32:35], s51 offen lds
    s_add_u32 m0, s53, 16384
    s_add_u32 s51, s50, 2048
    buffer_load_dwordx4 v14, s[32:35], s51 offen lds
    ds_read_b128 v[80:83], v8 offset:32768
    ds_read_b64_tr_b16 v[96:97], v62 offset:24576
    ds_read_b64_tr_b16 v[98:99], v62 offset:25088
    ds_read_b128 v[84:87], v9 offset:32768
    ds_read_b64_tr_b16 v[100:101], v62 offset:26624
    ds_read_b64_tr_b16 v[102:103], v62 offset:27136
    ds_read_b128 v[88:91], v10 offset:32768
    ds_read_b64_tr_b16 v[104:105], v62 offset:28672
    ds_read_b64_tr_b16 v[106:107], v62 offset:29184
    ds_read_b128 v[92:95], v11 offset:32768
    ds_read_b64_tr_b16 v[108:109], v62 offset:30720
    ds_read_b64_tr_b16 v[110:111], v62 offset:31232
    v_mfma_f32_32x32x16_bf16 v[64:79], v[128:131], v[112:115], v[64:79]
    v_mfma_f32_32x32x16_bf16 v[64:79], v[132:135], v[116:119], v[64:79]
    v_mfma_f32_32x32x16_bf16 v[64:79], v[136:139], v[120:123], v[64:79]
    v_mfma_f32_32x32x16_bf16 v[64:79], v[140:143], v[124:127], v[64:79]
    s_waitcnt lgkmcnt(0)
    s_waitcnt vmcnt(6)
    s_barrier
    ds_read_b128 v[112:115], v8 offset:40960
    ds_read_b64_tr_b16 v[128:129], v62 offset:0
    ds_read_b64_tr_b16 v[130:131], v62 offset:512
    ds_read_b128 v[116:119], v9 offset:40960
    ds_read_b64_tr_b16 v[132:133], v62 offset:2048
    ds_read_b64_tr_b16 v[134:135], v62 offset:2560
    ds_read_b128 v[120:123], v10 offset:40960
    ds_read_b64_tr_b16 v[136:137], v62 offset:4096
    ds_read_b64_tr_b16 v[138:139], v62 offset:4608
    ds_read_b128 v[124:127], v11 offset:40960
    ds_read_b64_tr_b16 v[140:141], v62 offset:6144
    ds_read_b64_tr_b16 v[142:143], v62 offset:6656
    v_mfma_f32_32x32x16_bf16 v[64:79], v[96:99], v[80:83], v[64:79]
    v_mfma_f32_32x32x16_bf16 v[64:79], v[100:103], v[84:87], v[64:79]
    v_mfma_f32_32x32x16_bf16 v[64:79], v[104:107], v[88:91], v[64:79]
    v_mfma_f32_32x32x16_bf16 v[64:79], v[108:111], v[92:95], v[64:79]
    s_waitcnt lgkmcnt(0)
    s_waitcnt vmcnt(3)
    s_barrier
    ds_read_b128 v[80:83], v8 offset:49152
    ds_read_b64_tr_b16 v[96:97], v12 offset:24576
    ds_read_b64_tr_b16 v[98:99], v12 offset:25088
    ds_read_b128 v[84:87], v9 offset:49152
    ds_read_b64_tr_b16 v[100:101], v12 offset:26624
    ds_read_b64_tr_b16 v[102:103], v12 offset:27136
    ds_read_b128 v[88:91], v10 offset:49152
    ds_read_b64_tr_b16 v[104:105], v12 offset:28672
    ds_read_b64_tr_b16 v[106:107], v12 offset:29184
    ds_read_b128 v[92:95], v11 offset:49152
    ds_read_b64_tr_b16 v[108:109], v12 offset:30720
    ds_read_b64_tr_b16 v[110:111], v12 offset:31232
    v_mfma_f32_32x32x16_bf16 v[64:79], v[128:131], v[112:115], v[64:79]
    v_mfma_f32_32x32x16_bf16 v[64:79], v[132:135], v[116:119], v[64:79]
    v_mfma_f32_32x32x16_bf16 v[64:79], v[136:139], v[120:123], v[64:79]
    v_mfma_f32_32x32x16_bf16 v[64:79], v[140:143], v[124:127], v[64:79]
    s_waitcnt lgkmcnt(0)
    s_waitcnt vmcnt(0)
    s_barrier
    ds_read_b128 v[112:115], v8 offset:57344
    ds_read_b64_tr_b16 v[128:129], v12 offset:0
    ds_read_b64_tr_b16 v[130:131], v12 offset:512
    ds_read_b128 v[116:119], v9 offset:57344
    ds_read_b64_tr_b16 v[132:133], v12 offset:2048
    ds_read_b64_tr_b16 v[134:135], v12 offset:2560
    ds_read_b128 v[120:123], v10 offset:57344
    ds_read_b64_tr_b16 v[136:137], v12 offset:4096
    ds_read_b64_tr_b16 v[138:139], v12 offset:4608
    ds_read_b128 v[124:127], v11 offset:57344
    ds_read_b64_tr_b16 v[140:141], v12 offset:6144
    ds_read_b64_tr_b16 v[142:143], v12 offset:6656
    v_mfma_f32_32x32x16_bf16 v[64:79], v[96:99], v[80:83], v[64:79]
    v_mfma_f32_32x32x16_bf16 v[64:79], v[100:103], v[84:87], v[64:79]
    v_mfma_f32_32x32x16_bf16 v[64:79], v[104:107], v[88:91], v[64:79]
    v_mfma_f32_32x32x16_bf16 v[64:79], v[108:111], v[92:95], v[64:79]
    s_waitcnt lgkmcnt(0)
    v_mfma_f32_32x32x16_bf16 v[64:79], v[128:131], v[112:115], v[64:79]
    v_mfma_f32_32x32x16_bf16 v[64:79], v[132:135], v[116:119], v[64:79]
    v_mfma_f32_32x32x16_bf16 v[64:79], v[136:139], v[120:123], v[64:79]
    v_mfma_f32_32x32x16_bf16 v[64:79], v[140:143], v[124:127], v[64:79]
    s_lshr_b32 s5, s40, 1
    s_and_b32 s5, s5, 1
    s_lshl_b32 s5, s5, 1
    s_lshl_b32 s6, s87, 2
    s_add_u32 s5, s5, s6
    s_lshl_b32 s5, s5, 6
    s_lshl_b32 s6, s86, 1
    s_add_u32 s5, s5, s6
    s_and_b32 s6, s40, 1
    s_add_u32 s5, s5, s6
    s_cmp_ge_u32 s40, 4
    s_cbranch_scc1 L_isk
    s_lshl_b32 s54, s5, 10
    s_add_u32 s54, s54, 27262976
    s_add_u32 s55, s54, 65536
    s_mov_b32 s56, 0x3eb8aa3b
    s_branch L_qk
L_isk:
    s_lshl_b32 s54, s5, 11
    s_add_u32 s54, s54, 2097152
    s_add_u32 s55, s54, 131072
    s_mov_b32 s56, 1.0
L_qk:
    s_nop 3
    v_mul_f32 v64, s56, v64
    v_mul_f32 v65, s56, v65
    v_mul_f32 v66, s56, v66
    v_mul_f32 v67, s56, v67
    v_mul_f32 v68, s56, v68
    v_mul_f32 v69, s56, v69
    v_mul_f32 v70, s56, v70
    v_mul_f32 v71, s56, v71
    v_mul_f32 v72, s56, v72
    v_mul_f32 v73, s56, v73
    v_mul_f32 v74, s56, v74
    v_mul_f32 v75, s56, v75
    v_mul_f32 v76, s56, v76
    v_mul_f32 v77, s56, v77
    v_mul_f32 v78, s56, v78
    v_mul_f32 v79, s56, v79
    v_cvt_pk_bf16_f32 v80, v64, v65
    v_cvt_pk_bf16_f32 v81, v66, v67
    v_cvt_pk_bf16_f32 v82, v68, v69
    v_cvt_pk_bf16_f32 v83, v70, v71
    v_cvt_pk_bf16_f32 v84, v72, v73
    v_cvt_pk_bf16_f32 v85, v74, v75
    v_cvt_pk_bf16_f32 v86, v76, v77
    v_cvt_pk_bf16_f32 v87, v78, v79
    buffer_store_dwordx4 v[80:83], v2, s[36:39], s54 offen sc1
    buffer_store_dwordx4 v[84:87], v2, s[36:39], s55 offen sc1
    s_lshl_b32 s53, s40, 11
    s_lshl_b32 s5, s40, 10
    s_add_u32 s5, s5, 24576
    v_add_u32 v4, s5, v2
    s_lshr_b32 s5, s40, 2
    s_lshl_b32 s5, s5, 1
    s_lshl_b32 s6, s87, 2
    s_add_u32 s5, s5, s6
    s_lshl_b32 s5, s5, 6
    s_lshl_b32 s6, s86, 1
    s_add_u32 s5, s5, s6
    s_bfe_u32 s6, s40, 0x10001
    s_add_u32 s5, s5, s6
    s_lshl_b32 s54, s5, 11
    s_and_b32 s58, s40, 1
    s_lshl_b32 s5, s58, 9
    s_add_u32 s54, s54, s5
    s_add_u32 s54, s54, 2097152
    v_bfe_u32 v3, v1, 4, 1
    v_lshlrev_b32 v3, 17, v3
    v_lshrrev_b32 v5, 5, v1
    v_lshl_add_u32 v3, v5, 8, v3
    v_and_b32 v5, 15, v1
    v_lshl_add_u32 v3, v5, 4, v3
    s_barrier
    ds_read_b128 v[88:91], v4
    s_lshl_b32 s76, s87, 12
    s_add_u32 s76, s76, 13893632
    v_mov_b32 v59, 157696
    s_lshl_b32 s5, s58, 3
    v_add_u32 v60, s5, v59
    s_waitcnt lgkmcnt(0)
    buffer_store_dwordx4 v[88:91], v3, s[36:39], s54 offen offset:1024 sc1
    s_waitcnt vmcnt(0)
    s_mov_b64 exec, 1
    v_mov_b32 v3, 1
    ds_add_u32 v59, v3 offset:176
    s_mov_b64 exec, -1
    s_cmp_lg_u32 s40, 0
    s_cbranch_scc1 L_nofl1
L_lw_10001:
    ds_read_b32 v3, v59 offset:176
    s_waitcnt lgkmcnt(0)
    v_readfirstlane_b32 s5, v3
    s_cmp_eq_u32 s5, 8
    s_cbranch_scc1 L_lwd_10002
    s_sleep 1
    s_add_u32 s83, s83, 1
    s_cmp_lt_u32 s83, 200000
    s_cbranch_scc1 L_lw_10001
    s_endpgm
L_lwd_10002:
    s_lshl_b32 s5, s86, 7
    s_add_u32 s5, s5, s76
    s_mov_b64 exec, 0xff
    v_mov_b32 v160, s82
    v_mov_b32 v161, s82
    v_mov_b32 v162, s82
    v_mov_b32 v163, s82
    buffer_store_dwordx4 v[160:163], v2, s[36:39], s5 offen sc1
    s_mov_b64 exec, -1
    s_nop 1
L_nofl1:
    s_lshl_b32 s59, s58, 13
    v_add_u32 v56, s59, v2
    v_lshrrev_b32 v4, 5, v1
    v_and_b32 v5, 15, v1
    v_lshlrev_b32 v5, 4, v5
    v_lshl_add_u32 v57, v4, 8, v5
    v_add_u32 v57, s59, v57
    s_mov_b32 s74, 0x0000ffff
    s_mov_b32 s75, 0x0000ffff
    v_and_b32 v3, 31, v1
    v_cmp_eq_u32 vcc, 16, v3
    v_mov_b32 v4, 0x3f803f80
    s_lshl_b32 s5, s41, 6
    s_lshl_b32 s6, s42, 3
    s_lshl_b32 s7, s72, 3
    s_add_u32 s7, s7, s5
    s_add_u32 s5, s5, s6
    s_add_u32 s6, s7, s40
    s_lshl_b32 s54, s6, 11
    s_add_u32 s54, s54, 2097152
    s_add_u32 s6, s40, s5
    s_lshl_b32 s55, s6, 10
    s_add_u32 s55, s55, 27262976
    s_xor_b32 s59, s55, 1024
    v_cndmask_b32 v24, 0, v4, vcc
    v_cndmask_b32 v25, 0, v4, vcc
    v_cndmask_b32 v26, 0, v4, vcc
    v_cndmask_b32 v27, 0, v4, vcc
    v_cndmask_b32 v28, 0, v4, vcc
    v_cndmask_b32 v29, 0, v4, vcc
    v_cndmask_b32 v30, 0, v4, vcc
    v_cndmask_b32 v31, 0, v4, vcc
    v_cndmask_b32 v32, 0, v4, vcc
    v_cndmask_b32 v33, 0, v4, vcc
    v_cndmask_b32 v34, 0, v4, vcc
    v_cndmask_b32 v35, 0, v4, vcc
    v_cndmask_b32 v36, 0, v4, vcc
    v_cndmask_b32 v37, 0, v4, vcc
    v_cndmask_b32 v38, 0, v4, vcc
    v_cndmask_b32 v39, 0, v4, vcc
    v_mov_b32 v128, 0
    v_mov_b32 v129, 0
    v_mov_b32 v130, 0
    v_mov_b32 v131, 0
    v_mov_b32 v132, 0
    v_mov_b32 v133, 0
    v_mov_b32 v134, 0
    v_mov_b32 v135, 0
    v_mov_b32 v136, 0
    v_mov_b32 v137, 0
    v_mov_b32 v138, 0
    v_mov_b32 v139, 0
    v_mov_b32 v140, 0
    v_mov_b32 v141, 0
    v_mov_b32 v142, 0
    v_mov_b32 v143, 0
    v_mov_b32 v144, 0
    v_mov_b32 v145, 0
    v_mov_b32 v146, 0
    v_mov_b32 v147, 0
    v_mov_b32 v148, 0
    v_mov_b32 v149, 0
    v_mov_b32 v150, 0
    v_mov_b32 v151, 0
    v_mov_b32 v152, 0
    v_mov_b32 v153, 0
    v_mov_b32 v154, 0
    v_mov_b32 v155, 0
    v_mov_b32 v156, 0
    v_mov_b32 v157, 0
    v_mov_b32 v158, 0
    v_mov_b32 v159, 0
    v_mov_b32 v48, 0
    v_mov_b32 v49, 0
    v_mov_b32 v50, 0
    v_mov_b32 v51, 0
    v_mov_b32 v52, 0
    v_mov_b32 v53, 0
    v_mov_b32 v54, 0
    v_mov_b32 v55, 0
    v_mov_b32 v62, 0xdddddddd
    s_lshl_b32 s76, s3, 12
    s_add_u32 s76, s76, 13893632
    s_lshl_b32 s5, s72, 2
    s_sub_u32 s5, s5, 4
    v_add_u32 v7, s5, v1
    v_and_b32 v7, 31, v7
    s_lshl_b32 s5, s42, 2
    v_add_u32 v6, s5, v1
    v_cmp_gt_u32 vcc, 4, v1
    v_cndmask_b32 v7, v7, v6, vcc
    v_lshlrev_b32 v7, 7, v7
    s_add_u32 s6, s54, s53
    s_add_u32 s5, s72, 1
    s_and_b32 s5, s5, 7
    s_sub_u32 s5, s5, s72
    s_lshl_b32 s5, s5, 14
    s_add_u32 s56, s6, s5
    s_add_u32 s5, s72, 2
    s_and_b32 s5, s5, 7
    s_sub_u32 s5, s5, s72
    s_lshl_b32 s5, s5, 14
    s_add_u32 s57, s6, s5
    s_mov_b32 m0, s53
    s_sub_u32 s5, s40, 1
    s_cmp_ge_u32 s5, 1
    s_cbranch_scc1 L_nopoll
L_lw_10003:
    ds_read_b32 v3, v59 offset:176
    s_waitcnt lgkmcnt(0)
    v_readfirstlane_b32 s5, v3
    s_cmp_eq_u32 s5, 8
    s_cbranch_scc1 L_lwd_10004
    s_sleep 1
    s_add_u32 s83, s83, 1
    s_cmp_lt_u32 s83, 200000
    s_cbranch_scc1 L_lw_10003
    s_endpgm
L_lwd_10004:
L_qp:
    s_mov_b64 exec, 0xfff
    buffer_load_dword v160, v7, s[36:39], s76 offen sc1
    s_waitcnt vmcnt(0)
    v_cmp_ne_u32 vcc, s82, v160
    s_mov_b64 exec, -1
    s_and_b32 s5, vcc_lo, 255
    s_cbranch_scc0 L_qok
    s_sleep 3
    s_add_u32 s83, s83, 1
    s_cmp_lt_u32 s83, 200000
    s_cbranch_scc1 L_qp
    s_endpgm
L_qok:
    s_cmp_eq_u32 vcc_lo, 0
    s_cselect_b32 s5, 3, 1
    v_mov_b32 v3, s5
    ds_max_u32 v59, v3 offset:32
L_nopoll:
L_qw:
    ds_read_b32 v3, v59 offset:32
    s_waitcnt lgkmcnt(0)
    v_readfirstlane_b32 s48, v3
    s_cmp_lg_u32 s48, 0
    s_cbranch_scc1 L_qwd
    s_sleep 1
    s_add_u32 s83, s83, 1
    s_cmp_lt_u32 s83, 200000
    s_cbranch_scc1 L_qw
    s_endpgm
L_qwd:
    buffer_load_dwordx4 v2, s[36:39], s54 offen sc1 lds
    buffer_load_dwordx4 v2, s[36:39], s54 offen offset:1024 sc1 lds
    buffer_load_dwordx4 v[12:15], v2, s[36:39], s55 offen sc1
    buffer_load_dwordx4 v[8:11], v2, s[36:39], s59 offen sc1
    s_cmp_ge_u32 s40, 4
    s_cbranch_scc1 L_young
    s_cmp_eq_u32 s48, 3
    s_cbranch_scc1 L_nop2
    s_cmp_lg_u32 s40, 1
    s_cbranch_scc1 L_nop2
    s_mov_b64 exec, 0xfff
    buffer_load_dword v160, v7, s[36:39], s76 offen sc1
    s_mov_b64 exec, -1
    s_waitcnt vmcnt(3)
    s_mov_b64 exec, 1
    v_mov_b32 v3, 1
    ds_add_u32 v59, v3 offset:184
    s_mov_b64 exec, -1
    s_branch L_qp3
L_qp2:
    s_mov_b64 exec, 0xfff
    buffer_load_dword v160, v7, s[36:39], s76 offen sc1
L_qp3:
    s_mov_b64 exec, 0xfff
    s_waitcnt vmcnt(0)
    v_cmp_ne_u32 vcc, s82, v160
    s_mov_b64 exec, -1
    s_cmp_eq_u32 vcc_lo, 0
    s_cbranch_scc1 L_qok2
    s_sleep 3
    s_add_u32 s83, s83, 1
    s_cmp_lt_u32 s83, 200000
    s_cbranch_scc1 L_qp2
    s_endpgm
L_qok2:
    v_mov_b32 v3, 3
    ds_write_b32 v59, v3 offset:32
    s_branch L_q3
L_nop2:
    s_waitcnt vmcnt(2)
    s_mov_b64 exec, 1
    v_mov_b32 v3, 1
    ds_add_u32 v59, v3 offset:184
    s_mov_b64 exec, -1
L_lw_10005:
    ds_read_b32 v3, v59 offset:32
    s_waitcnt lgkmcnt(0)
    v_readfirstlane_b32 s5, v3
    s_cmp_eq_u32 s5, 3
    s_cbranch_scc1 L_lwd_10006
    s_sleep 1
    s_add_u32 s83, s83, 1
    s_cmp_lt_u32 s83, 200000
    s_cbranch_scc1 L_lw_10005
    s_endpgm
L_lwd_10006:
L_q3:
    s_lshl_b32 s6, s53, 1
    s_add_u32 m0, s6, 16384
    s_nop 0
    buffer_load_dwordx4 v2, s[36:39], s56 offen offset:0 sc1 lds
    buffer_load_dwordx4 v2, s[36:39], s56 offen offset:1024 sc1 lds
    buffer_load_dwordx4 v2, s[36:39], s56 offen offset:2048 sc1 lds
    buffer_load_dwordx4 v2, s[36:39], s56 offen offset:3072 sc1 lds
    s_cmp_lg_u32 s48, 7
    s_cbranch_scc1 L_s0done
    s_waitcnt vmcnt(10)
    s_mov_b64 exec, 1
    v_mov_b32 v3, 1
    ds_add_u32 v59, v3 offset:184
    s_mov_b64 exec, -1
L_s0done:
    s_waitcnt vmcnt(0)
    s_mov_b64 exec, 1
    v_mov_b32 v3, 1
    ds_add_u32 v59, v3 offset:188
    s_mov_b64 exec, -1
    s_branch L_go
L_young:
    s_waitcnt vmcnt(2)
    s_mov_b64 exec, 1
    v_mov_b32 v3, 1
    ds_add_u32 v59, v3 offset:184
    s_mov_b64 exec, -1
    s_waitcnt vmcnt(0)
L_go:
L_lw_10007:
    ds_read_b32 v3, v59 offset:184
    s_waitcnt lgkmcnt(0)
    v_readfirstlane_b32 s5, v3
    s_cmp_eq_u32 s5, 8
    s_cbranch_scc1 L_lwd_10008
    s_sleep 1
    s_add_u32 s83, s83, 1
    s_cmp_lt_u32 s83, 200000
    s_cbranch_scc1 L_lw_10007
    s_endpgm
L_lwd_10008:
    ds_read_b128 v[16:19], v2
    s_waitcnt lgkmcnt(0)
    v_mfma_f32_32x32x16_bf16 v[64:79], v[16:19], v[8:11], 0
    v_mfma_f32_32x32x16_bf16 v[80:95], v[16:19], v[12:15], 0
    s_mov_b32 s77, 0
    s_nop 7
    ds_read_b128 v[16:19], v56
    s_mov_b64 exec, s[74:75]
    ds_read_b128 v[24:27], v57 offset:1024
    ds_read_b128 v[28:31], v57 offset:1536
    s_mov_b64 exec, -1
    s_nop 4
    v_max3_f32 v3, v64, v65, v66
    v_max3_f32 v3, v3, v67, v68
    v_max3_f32 v3, v3, v69, v70
    v_max3_f32 v3, v3, v71, v72
    v_max3_f32 v3, v3, v73, v74
    v_max3_f32 v3, v3, v75, v76
    v_max3_f32 v3, v3, v77, v78
    v_max_f32 v3, v3, v79
    v_max3_f32 v4, v80, v81, v82
    v_max3_f32 v4, v4, v83, v84
    v_max3_f32 v4, v4, v85, v86
    v_max3_f32 v4, v4, v87, v88
    v_max3_f32 v4, v4, v89, v90
    v_max3_f32 v4, v4, v91, v92
    v_max3_f32 v4, v4, v93, v94
    v_max_f32 v4, v4, v95
    v_mov_b32 v5, v3
    v_mov_b32 v6, v4
    s_nop 1
    v_permlane32_swap_b32 v3, v5
    v_permlane32_swap_b32 v4, v6
    s_nop 1
    v_max_f32 v3, v3, v5
    v_max_f32 v4, v4, v6
    v_sub_f32 v96, 0, v3
    v_sub_f32 v97, 0, v3
    v_sub_f32 v98, 0, v3
    v_sub_f32 v99, 0, v3
    v_sub_f32 v100, 0, v3
    v_sub_f32 v101, 0, v3
    v_sub_f32 v102, 0, v3
    v_sub_f32 v103, 0, v3
    v_sub_f32 v104, 0, v3
    v_sub_f32 v105, 0, v3
    v_sub_f32 v106, 0, v3
    v_sub_f32 v107, 0, v3
    v_sub_f32 v108, 0, v3
    v_sub_f32 v109, 0, v3
    v_sub_f32 v110, 0, v3
    v_sub_f32 v111, 0, v3
    v_sub_f32 v112, 0, v4
    v_sub_f32 v113, 0, v4
    v_sub_f32 v114, 0, v4
    v_sub_f32 v115, 0, v4
    v_sub_f32 v116, 0, v4
    v_sub_f32 v117, 0, v4
    v_sub_f32 v118, 0, v4
    v_sub_f32 v119, 0, v4
    v_sub_f32 v120, 0, v4
    v_sub_f32 v121, 0, v4
    v_sub_f32 v122, 0, v4
    v_sub_f32 v123, 0, v4
    v_sub_f32 v124, 0, v4
    v_sub_f32 v125, 0, v4
    v_sub_f32 v126, 0, v4
    v_sub_f32 v127, 0, v4
    s_waitcnt lgkmcnt(0)
    v_mfma_f32_32x32x16_bf16 v[64:79], v[16:19], v[8:11], v[96:111]
    s_nop 7
    s_nop 4
    s_cmp_lt_u32 s40, 4
    s_cbranch_scc1 L_bal0
    s_setprio 1
L_bal0:
    v_mfma_f32_32x32x16_bf16 v[80:95], v[16:19], v[12:15], v[112:127]
    ds_read_b128 v[20:23], v56 offset:2048
    v_exp_f32 v64, v64
    v_exp_f32 v65, v65
    v_exp_f32 v66, v66
    v_exp_f32 v67, v67
    v_exp_f32 v68, v68
    v_exp_f32 v69, v69
    v_smfmac_f32_32x32x32_bf16 v[144:159], v[36:39], v[48:55], v62
    s_mov_b64 exec, s[74:75]
    ds_read_b128 v[32:35], v57 offset:3072
    ds_read_b128 v[36:39], v57 offset:3584
    s_mov_b64 exec, -1
    v_exp_f32 v70, v70
    v_exp_f32 v71, v71
    v_exp_f32 v40, v72
    v_exp_f32 v41, v73
    v_exp_f32 v42, v74
    v_smfmac_f32_32x32x32_bf16 v[128:143], v[24:27], v[64:71], v62
    v_exp_f32 v43, v75
    v_exp_f32 v44, v76
    v_exp_f32 v45, v77
    v_exp_f32 v46, v78
    v_exp_f32 v47, v79
    s_waitcnt lgkmcnt(0)
    v_mfma_f32_32x32x16_bf16 v[64:79], v[20:23], v[8:11], v[96:111]
    v_exp_f32 v80, v80
    v_exp_f32 v81, v81
    v_exp_f32 v82, v82
    v_exp_f32 v83, v83
    v_exp_f32 v84, v84
    v_exp_f32 v85, v85
    v_smfmac_f32_32x32x32_bf16 v[128:143], v[28:31], v[40:47], v62
    v_exp_f32 v86, v86
    v_exp_f32 v87, v87
    v_exp_f32 v48, v88
    v_exp_f32 v49, v89
    v_exp_f32 v50, v90
    v_smfmac_f32_32x32x32_bf16 v[144:159], v[24:27], v[80:87], v62
    v_exp_f32 v51, v91
    v_exp_f32 v52, v92
    v_exp_f32 v53, v93
    v_exp_f32 v54, v94
    v_exp_f32 v55, v95
    v_mfma_f32_32x32x16_bf16 v[80:95], v[20:23], v[12:15], v[112:127]
    ds_read_b128 v[16:19], v56 offset:4096
    v_exp_f32 v64, v64
    v_exp_f32 v65, v65
    v_exp_f32 v66, v66
    v_exp_f32 v67, v67
    v_exp_f32 v68, v68
    v_exp_f32 v69, v69
    v_smfmac_f32_32x32x32_bf16 v[144:159], v[28:31], v[48:55], v62
    s_mov_b64 exec, s[74:75]
    ds_read_b128 v[24:27], v57 offset:5120
    ds_read_b128 v[28:31], v57 offset:5632
    s_mov_b64 exec, -1
    v_exp_f32 v70, v70
    v_exp_f32 v71, v71
    v_exp_f32 v40, v72
    v_exp_f32 v41, v73
    v_exp_f32 v42, v74
    v_smfmac_f32_32x32x32_bf16 v[128:143], v[32:35], v[64:71], v62
    v_exp_f32 v43, v75
    v_exp_f32 v44, v76
    v_exp_f32 v45, v77
    v_exp_f32 v46, v78
    v_exp_f32 v47, v79
    s_waitcnt lgkmcnt(0)
    v_mfma_f32_32x32x16_bf16 v[64:79], v[16:19], v[8:11], v[96:111]
    v_exp_f32 v80, v80
    v_exp_f32 v81, v81
    v_exp_f32 v82, v82
    v_exp_f32 v83, v83
    v_exp_f32 v84, v84
    v_exp_f32 v85, v85
    v_smfmac_f32_32x32x32_bf16 v[128:143], v[36:39], v[40:47], v62
    v_exp_f32 v86, v86
    v_exp_f32 v87, v87
    v_exp_f32 v48, v88
    v_exp_f32 v49, v89
    v_exp_f32 v50, v90
    v_smfmac_f32_32x32x32_bf16 v[144:159], v[32:35], v[80:87], v62
    v_exp_f32 v51, v91
    v_exp_f32 v52, v92
    v_exp_f32 v53, v93
    v_exp_f32 v54, v94
    v_exp_f32 v55, v95
    v_mfma_f32_32x32x16_bf16 v[80:95], v[16:19], v[12:15], v[112:127]
    ds_read_b128 v[20:23], v56 offset:6144
    v_exp_f32 v64, v64
    v_exp_f32 v65, v65
    v_exp_f32 v66, v66
    v_exp_f32 v67, v67
    v_exp_f32 v68, v68
    v_exp_f32 v69, v69
    v_smfmac_f32_32x32x32_bf16 v[144:159], v[36:39], v[48:55], v62
    s_mov_b64 exec, s[74:75]
    ds_read_b128 v[32:35], v57 offset:7168
    ds_read_b128 v[36:39], v57 offset:7680
    s_mov_b64 exec, -1
    v_exp_f32 v70, v70
    v_exp_f32 v71, v71
    v_exp_f32 v40, v72
    v_exp_f32 v41, v73
    v_exp_f32 v42, v74
    v_smfmac_f32_32x32x32_bf16 v[128:143], v[24:27], v[64:71], v62
    v_exp_f32 v43, v75
    v_exp_f32 v44, v76
    v_exp_f32 v45, v77
    v_exp_f32 v46, v78
    v_exp_f32 v47, v79
    s_waitcnt lgkmcnt(0)
    v_mfma_f32_32x32x16_bf16 v[64:79], v[20:23], v[8:11], v[96:111]
    v_exp_f32 v80, v80
    v_exp_f32 v81, v81
    v_exp_f32 v82, v82
    v_exp_f32 v83, v83
    v_exp_f32 v84, v84
    v_exp_f32 v85, v85
    v_smfmac_f32_32x32x32_bf16 v[128:143], v[28:31], v[40:47], v62
    v_exp_f32 v86, v86
    v_exp_f32 v87, v87
    v_exp_f32 v48, v88
    v_exp_f32 v49, v89
    v_exp_f32 v50, v90
    v_smfmac_f32_32x32x32_bf16 v[144:159], v[24:27], v[80:87], v62
    v_exp_f32 v51, v91
    v_exp_f32 v52, v92
    v_exp_f32 v53, v93
    v_exp_f32 v54, v94
    v_exp_f32 v55, v95
L_lw_10009:
    ds_read_b32 v4, v59 offset:188
    s_waitcnt lgkmcnt(0)
    v_readfirstlane_b32 s5, v4
    s_cmp_eq_u32 s5, 4
    s_cbranch_scc1 L_lwd_10010
    s_sleep 1
    s_add_u32 s83, s83, 1
    s_cmp_lt_u32 s83, 200000
    s_cbranch_scc1 L_lw_10009
    s_endpgm
L_lwd_10010:
    v_mfma_f32_32x32x16_bf16 v[80:95], v[20:23], v[12:15], v[112:127]
    ds_read_b128 v[16:19], v56 offset:16384
    v_exp_f32 v64, v64
    v_exp_f32 v65, v65
    v_exp_f32 v66, v66
    v_exp_f32 v67, v67
    v_exp_f32 v68, v68
    v_exp_f32 v69, v69
    v_smfmac_f32_32x32x32_bf16 v[144:159], v[28:31], v[48:55], v62
    s_mov_b64 exec, s[74:75]
    ds_read_b128 v[24:27], v57 offset:17408
    ds_read_b128 v[28:31], v57 offset:17920
    s_mov_b64 exec, -1
    v_exp_f32 v70, v70
    v_exp_f32 v71, v71
    v_exp_f32 v40, v72
    v_exp_f32 v41, v73
    v_exp_f32 v42, v74
    v_smfmac_f32_32x32x32_bf16 v[128:143], v[32:35], v[64:71], v62
    v_exp_f32 v43, v75
    v_exp_f32 v44, v76
    v_exp_f32 v45, v77
    v_exp_f32 v46, v78
    v_exp_f32 v47, v79
    s_waitcnt lgkmcnt(0)
    v_mfma_f32_32x32x16_bf16 v[64:79], v[16:19], v[8:11], v[96:111]
    v_exp_f32 v80, v80
    v_exp_f32 v81, v81
    v_exp_f32 v82, v82
    v_exp_f32 v83, v83
    v_exp_f32 v84, v84
    v_exp_f32 v85, v85
    v_smfmac_f32_32x32x32_bf16 v[128:143], v[36:39], v[40:47], v62
    v_exp_f32 v86, v86
    v_exp_f32 v87, v87
    v_exp_f32 v48, v88
    v_exp_f32 v49, v89
    v_exp_f32 v50, v90
    v_smfmac_f32_32x32x32_bf16 v[144:159], v[32:35], v[80:87], v62
    v_exp_f32 v51, v91
    v_exp_f32 v52, v92
    v_exp_f32 v53, v93
    v_exp_f32 v54, v94
    v_exp_f32 v55, v95
    v_add_u32 v56, 16384, v56
    v_add_u32 v57, 16384, v57
    v_mfma_f32_32x32x16_bf16 v[80:95], v[16:19], v[12:15], v[112:127]
    ds_read_b128 v[20:23], v56 offset:2048
    v_exp_f32 v64, v64
    v_exp_f32 v65, v65
    v_exp_f32 v66, v66
    v_exp_f32 v67, v67
    v_exp_f32 v68, v68
    v_exp_f32 v69, v69
    v_smfmac_f32_32x32x32_bf16 v[144:159], v[36:39], v[48:55], v62
    s_mov_b64 exec, s[74:75]
    ds_read_b128 v[32:35], v57 offset:3072
    ds_read_b128 v[36:39], v57 offset:3584
    s_mov_b64 exec, -1
    v_exp_f32 v70, v70
    v_exp_f32 v71, v71
    v_exp_f32 v40, v72
    v_exp_f32 v41, v73
    v_exp_f32 v42, v74
    v_smfmac_f32_32x32x32_bf16 v[128:143], v[24:27], v[64:71], v62
    v_exp_f32 v43, v75
    v_exp_f32 v44, v76
    v_exp_f32 v45, v77
    v_exp_f32 v46, v78
    v_exp_f32 v47, v79
    s_waitcnt lgkmcnt(0)
    v_mfma_f32_32x32x16_bf16 v[64:79], v[20:23], v[8:11], v[96:111]
    v_exp_f32 v80, v80
    v_exp_f32 v81, v81
    v_exp_f32 v82, v82
    v_exp_f32 v83, v83
    v_exp_f32 v84, v84
    v_exp_f32 v85, v85
    v_smfmac_f32_32x32x32_bf16 v[128:143], v[28:31], v[40:47], v62
    v_exp_f32 v86, v86
    v_exp_f32 v87, v87
    v_exp_f32 v48, v88
    v_exp_f32 v49, v89
    v_exp_f32 v50, v90
    v_smfmac_f32_32x32x32_bf16 v[144:159], v[24:27], v[80:87], v62
    v_exp_f32 v51, v91
    v_exp_f32 v52, v92
    v_exp_f32 v53, v93
    v_exp_f32 v54, v94
    v_exp_f32 v55, v95
    v_mfma_f32_32x32x16_bf16 v[80:95], v[20:23], v[12:15], v[112:127]
    ds_read_b128 v[16:19], v56 offset:4096
    v_exp_f32 v64, v64
    v_exp_f32 v65, v65
    v_exp_f32 v66, v66
    v_exp_f32 v67, v67
    v_exp_f32 v68, v68
    v_exp_f32 v69, v69
    v_smfmac_f32_32x32x32_bf16 v[144:159], v[28:31], v[48:55], v62
    s_mov_b64 exec, s[74:75]
    ds_read_b128 v[24:27], v57 offset:5120
    ds_read_b128 v[28:31], v57 offset:5632
    s_mov_b64 exec, -1
    v_exp_f32 v70, v70
    v_exp_f32 v71, v71
    v_exp_f32 v40, v72
    v_exp_f32 v41, v73
    v_exp_f32 v42, v74
    v_smfmac_f32_32x32x32_bf16 v[128:143], v[32:35], v[64:71], v62
    v_exp_f32 v43, v75
    v_exp_f32 v44, v76
    v_exp_f32 v45, v77
    v_exp_f32 v46, v78
    v_exp_f32 v47, v79
    s_waitcnt lgkmcnt(0)
    v_mfma_f32_32x32x16_bf16 v[64:79], v[16:19], v[8:11], v[96:111]
    v_exp_f32 v80, v80
    v_exp_f32 v81, v81
    v_exp_f32 v82, v82
    v_exp_f32 v83, v83
    v_exp_f32 v84, v84
    v_exp_f32 v85, v85
    v_smfmac_f32_32x32x32_bf16 v[128:143], v[36:39], v[40:47], v62
    v_exp_f32 v86, v86
    v_exp_f32 v87, v87
    v_exp_f32 v48, v88
    v_exp_f32 v49, v89
    v_exp_f32 v50, v90
    v_smfmac_f32_32x32x32_bf16 v[144:159], v[32:35], v[80:87], v62
    v_exp_f32 v51, v91
    v_exp_f32 v52, v92
    v_exp_f32 v53, v93
    v_exp_f32 v54, v94
    v_exp_f32 v55, v95
    v_mfma_f32_32x32x16_bf16 v[80:95], v[16:19], v[12:15], v[112:127]
    ds_read_b128 v[20:23], v56 offset:6144
    v_exp_f32 v64, v64
    v_exp_f32 v65, v65
    v_exp_f32 v66, v66
    v_exp_f32 v67, v67
    v_exp_f32 v68, v68
    v_exp_f32 v69, v69
    v_smfmac_f32_32x32x32_bf16 v[144:159], v[36:39], v[48:55], v62
    s_mov_b64 exec, s[74:75]
    ds_read_b128 v[32:35], v57 offset:7168
    ds_read_b128 v[36:39], v57 offset:7680
    s_mov_b64 exec, -1
    v_exp_f32 v70, v70
    v_exp_f32 v71, v71
    v_exp_f32 v40, v72
    v_exp_f32 v41, v73
    v_exp_f32 v42, v74
    v_smfmac_f32_32x32x32_bf16 v[128:143], v[24:27], v[64:71], v62
    v_exp_f32 v43, v75
    v_exp_f32 v44, v76
    v_exp_f32 v45, v77
    v_exp_f32 v46, v78
    v_exp_f32 v47, v79
    s_waitcnt lgkmcnt(0)
    v_mfma_f32_32x32x16_bf16 v[64:79], v[20:23], v[8:11], v[96:111]
    v_exp_f32 v80, v80
    v_exp_f32 v81, v81
    v_exp_f32 v82, v82
    v_exp_f32 v83, v83
    v_exp_f32 v84, v84
    v_exp_f32 v85, v85
    v_smfmac_f32_32x32x32_bf16 v[128:143], v[28:31], v[40:47], v62
    v_exp_f32 v86, v86
    v_exp_f32 v87, v87
    v_exp_f32 v48, v88
    v_exp_f32 v49, v89
    v_exp_f32 v50, v90
    v_smfmac_f32_32x32x32_bf16 v[144:159], v[24:27], v[80:87], v62
    v_exp_f32 v51, v91
    v_exp_f32 v52, v92
    v_exp_f32 v53, v93
    v_exp_f32 v54, v94
    v_exp_f32 v55, v95
L_pw_10011:
    ds_read_b64 v[4:5], v60 offset:0
    s_waitcnt lgkmcnt(0)
    v_min_u32 v4, v4, v5
    s_nop 0
    v_readfirstlane_b32 s5, v4
    s_cmp_ge_u32 s5, 5
    s_cbranch_scc1 L_pwd_10012
    s_sleep 1
    s_add_u32 s83, s83, 1
    s_cmp_lt_u32 s83, 200000
    s_cbranch_scc1 L_pw_10011
    s_endpgm
L_pwd_10012:
    v_mfma_f32_32x32x16_bf16 v[80:95], v[20:23], v[12:15], v[112:127]
    ds_read_b128 v[16:19], v56 offset:16384
    v_exp_f32 v64, v64
    v_exp_f32 v65, v65
    v_exp_f32 v66, v66
    v_exp_f32 v67, v67
    v_exp_f32 v68, v68
    v_exp_f32 v69, v69
    v_smfmac_f32_32x32x32_bf16 v[144:159], v[28:31], v[48:55], v62
    s_mov_b64 exec, s[74:75]
    ds_read_b128 v[24:27], v57 offset:17408
    ds_read_b128 v[28:31], v57 offset:17920
    s_mov_b64 exec, -1
    v_exp_f32 v70, v70
    v_exp_f32 v71, v71
    v_exp_f32 v40, v72
    v_exp_f32 v41, v73
    v_exp_f32 v42, v74
    v_smfmac_f32_32x32x32_bf16 v[128:143], v[32:35], v[64:71], v62
    v_exp_f32 v43, v75
    v_exp_f32 v44, v76
    v_exp_f32 v45, v77
    v_exp_f32 v46, v78
    v_exp_f32 v47, v79
    s_waitcnt lgkmcnt(0)
    v_mfma_f32_32x32x16_bf16 v[64:79], v[16:19], v[8:11], v[96:111]
    v_exp_f32 v80, v80
    v_exp_f32 v81, v81
    v_exp_f32 v82, v82
    v_exp_f32 v83, v83
    v_exp_f32 v84, v84
    v_exp_f32 v85, v85
    v_smfmac_f32_32x32x32_bf16 v[128:143], v[36:39], v[40:47], v62
    v_exp_f32 v86, v86
    v_exp_f32 v87, v87
    v_exp_f32 v48, v88
    v_exp_f32 v49, v89
    v_exp_f32 v50, v90
    v_smfmac_f32_32x32x32_bf16 v[144:159], v[32:35], v[80:87], v62
    v_exp_f32 v51, v91
    v_exp_f32 v52, v92
    v_exp_f32 v53, v93
    v_exp_f32 v54, v94
    v_exp_f32 v55, v95
    v_add_u32 v56, 16384, v56
    v_add_u32 v57, 16384, v57
    v_mfma_f32_32x32x16_bf16 v[80:95], v[16:19], v[12:15], v[112:127]
    ds_read_b128 v[20:23], v56 offset:2048
    v_exp_f32 v64, v64
    v_exp_f32 v65, v65
    v_exp_f32 v66, v66
    v_exp_f32 v67, v67
    v_exp_f32 v68, v68
    v_exp_f32 v69, v69
    v_smfmac_f32_32x32x32_bf16 v[144:159], v[36:39], v[48:55], v62
    s_mov_b64 exec, s[74:75]
    ds_read_b128 v[32:35], v57 offset:3072
    ds_read_b128 v[36:39], v57 offset:3584
    s_mov_b64 exec, -1
    v_exp_f32 v70, v70
    v_exp_f32 v71, v71
    v_exp_f32 v40, v72
    v_exp_f32 v41, v73
    v_exp_f32 v42, v74
    v_smfmac_f32_32x32x32_bf16 v[128:143], v[24:27], v[64:71], v62
    v_exp_f32 v43, v75
    v_exp_f32 v44, v76
    v_exp_f32 v45, v77
    v_exp_f32 v46, v78
    v_exp_f32 v47, v79
    s_waitcnt lgkmcnt(0)
    v_mfma_f32_32x32x16_bf16 v[64:79], v[20:23], v[8:11], v[96:111]
    v_exp_f32 v80, v80
    v_exp_f32 v81, v81
    v_exp_f32 v82, v82
    v_exp_f32 v83, v83
    v_exp_f32 v84, v84
    v_exp_f32 v85, v85
    v_smfmac_f32_32x32x32_bf16 v[128:143], v[28:31], v[40:47], v62
    v_exp_f32 v86, v86
    v_exp_f32 v87, v87
    v_exp_f32 v48, v88
    v_exp_f32 v49, v89
    v_exp_f32 v50, v90
    v_smfmac_f32_32x32x32_bf16 v[144:159], v[24:27], v[80:87], v62
    v_exp_f32 v51, v91
    v_exp_f32 v52, v92
    v_exp_f32 v53, v93
    v_exp_f32 v54, v94
    v_exp_f32 v55, v95
    v_mfma_f32_32x32x16_bf16 v[80:95], v[20:23], v[12:15], v[112:127]
    ds_read_b128 v[16:19], v56 offset:4096
    v_exp_f32 v64, v64
    v_exp_f32 v65, v65
    v_exp_f32 v66, v66
    v_exp_f32 v67, v67
    v_exp_f32 v68, v68
    v_exp_f32 v69, v69
    v_smfmac_f32_32x32x32_bf16 v[144:159], v[28:31], v[48:55], v62
    s_mov_b64 exec, s[74:75]
    ds_read_b128 v[24:27], v57 offset:5120
    ds_read_b128 v[28:31], v57 offset:5632
    s_mov_b64 exec, -1
    v_exp_f32 v70, v70
    v_exp_f32 v71, v71
    v_exp_f32 v40, v72
    v_exp_f32 v41, v73
    v_exp_f32 v42, v74
    v_smfmac_f32_32x32x32_bf16 v[128:143], v[32:35], v[64:71], v62
    v_exp_f32 v43, v75
    v_exp_f32 v44, v76
    v_exp_f32 v45, v77
    v_exp_f32 v46, v78
    v_exp_f32 v47, v79
    s_waitcnt lgkmcnt(0)
    v_mfma_f32_32x32x16_bf16 v[64:79], v[16:19], v[8:11], v[96:111]
    v_exp_f32 v80, v80
    v_exp_f32 v81, v81
    v_exp_f32 v82, v82
    v_exp_f32 v83, v83
    v_exp_f32 v84, v84
    v_exp_f32 v85, v85
    v_smfmac_f32_32x32x32_bf16 v[128:143], v[36:39], v[40:47], v62
    v_exp_f32 v86, v86
    v_exp_f32 v87, v87
    v_exp_f32 v48, v88
    v_exp_f32 v49, v89
    v_exp_f32 v50, v90
    v_smfmac_f32_32x32x32_bf16 v[144:159], v[32:35], v[80:87], v62
    v_exp_f32 v51, v91
    v_exp_f32 v52, v92
    v_exp_f32 v53, v93
    v_exp_f32 v54, v94
    v_exp_f32 v55, v95
    v_mfma_f32_32x32x16_bf16 v[80:95], v[16:19], v[12:15], v[112:127]
    ds_read_b128 v[20:23], v56 offset:6144
    v_exp_f32 v64, v64
    v_exp_f32 v65, v65
    v_exp_f32 v66, v66
    v_exp_f32 v67, v67
    v_exp_f32 v68, v68
    v_exp_f32 v69, v69
    v_smfmac_f32_32x32x32_bf16 v[144:159], v[36:39], v[48:55], v62
    s_mov_b64 exec, s[74:75]
    ds_read_b128 v[32:35], v57 offset:7168
    ds_read_b128 v[36:39], v57 offset:7680
    s_mov_b64 exec, -1
    v_exp_f32 v70, v70
    v_exp_f32 v71, v71
    v_exp_f32 v40, v72
    v_exp_f32 v41, v73
    v_exp_f32 v42, v74
    v_smfmac_f32_32x32x32_bf16 v[128:143], v[24:27], v[64:71], v62
    v_exp_f32 v43, v75
    v_exp_f32 v44, v76
    v_exp_f32 v45, v77
    v_exp_f32 v46, v78
    v_exp_f32 v47, v79
    s_waitcnt lgkmcnt(0)
    v_mfma_f32_32x32x16_bf16 v[64:79], v[20:23], v[8:11], v[96:111]
    v_exp_f32 v80, v80
    v_exp_f32 v81, v81
    v_exp_f32 v82, v82
    v_exp_f32 v83, v83
    v_exp_f32 v84, v84
    v_exp_f32 v85, v85
    v_smfmac_f32_32x32x32_bf16 v[128:143], v[28:31], v[40:47], v62
    v_exp_f32 v86, v86
    v_exp_f32 v87, v87
    v_exp_f32 v48, v88
    v_exp_f32 v49, v89
    v_exp_f32 v50, v90
    v_smfmac_f32_32x32x32_bf16 v[144:159], v[24:27], v[80:87], v62
    v_exp_f32 v51, v91
    v_exp_f32 v52, v92
    v_exp_f32 v53, v93
    v_exp_f32 v54, v94
    v_exp_f32 v55, v95
L_pw_10013:
    ds_read_b64 v[4:5], v60 offset:0
    s_waitcnt lgkmcnt(0)
    v_min_u32 v4, v4, v5
    s_nop 0
    v_readfirstlane_b32 s5, v4
    s_cmp_ge_u32 s5, 5
    s_cbranch_scc1 L_pwd_10014
    s_sleep 1
    s_add_u32 s83, s83, 1
    s_cmp_lt_u32 s83, 200000
    s_cbranch_scc1 L_pw_10013
    s_endpgm
L_pwd_10014:
    v_mfma_f32_32x32x16_bf16 v[80:95], v[20:23], v[12:15], v[112:127]
    ds_read_b128 v[16:19], v56 offset:16384
    v_exp_f32 v64, v64
    v_exp_f32 v65, v65
    v_exp_f32 v66, v66
    v_exp_f32 v67, v67
    v_exp_f32 v68, v68
    v_exp_f32 v69, v69
    v_smfmac_f32_32x32x32_bf16 v[144:159], v[28:31], v[48:55], v62
    s_mov_b64 exec, s[74:75]
    ds_read_b128 v[24:27], v57 offset:17408
    ds_read_b128 v[28:31], v57 offset:17920
    s_mov_b64 exec, -1
    v_exp_f32 v70, v70
    v_exp_f32 v71, v71
    v_exp_f32 v40, v72
    v_exp_f32 v41, v73
    v_exp_f32 v42, v74
    v_smfmac_f32_32x32x32_bf16 v[128:143], v[32:35], v[64:71], v62
    v_exp_f32 v43, v75
    v_exp_f32 v44, v76
    v_exp_f32 v45, v77
    v_exp_f32 v46, v78
    v_exp_f32 v47, v79
    s_waitcnt lgkmcnt(0)
    v_mfma_f32_32x32x16_bf16 v[64:79], v[16:19], v[8:11], v[96:111]
    v_exp_f32 v80, v80
    v_exp_f32 v81, v81
    v_exp_f32 v82, v82
    v_exp_f32 v83, v83
    v_exp_f32 v84, v84
    v_exp_f32 v85, v85
    v_smfmac_f32_32x32x32_bf16 v[128:143], v[36:39], v[40:47], v62
    v_exp_f32 v86, v86
    v_exp_f32 v87, v87
    v_exp_f32 v48, v88
    v_exp_f32 v49, v89
    v_exp_f32 v50, v90
    v_smfmac_f32_32x32x32_bf16 v[144:159], v[32:35], v[80:87], v62
    v_exp_f32 v51, v91
    v_exp_f32 v52, v92
    v_exp_f32 v53, v93
    v_exp_f32 v54, v94
    v_exp_f32 v55, v95
    v_add_u32 v56, 16384, v56
    v_add_u32 v57, 16384, v57
    s_mov_b32 s79, 3
L_att_loop:
    v_mfma_f32_32x32x16_bf16 v[80:95], v[16:19], v[12:15], v[112:127]
    ds_read_b128 v[20:23], v56 offset:2048
    v_exp_f32 v64, v64
    v_exp_f32 v65, v65
    v_exp_f32 v66, v66
    v_exp_f32 v67, v67
    v_exp_f32 v68, v68
    v_exp_f32 v69, v69
    v_smfmac_f32_32x32x32_bf16 v[144:159], v[36:39], v[48:55], v62
    s_mov_b64 exec, s[74:75]
    ds_read_b128 v[32:35], v57 offset:3072
    ds_read_b128 v[36:39], v57 offset:3584
    s_mov_b64 exec, -1
    v_exp_f32 v70, v70
    v_exp_f32 v71, v71
    v_exp_f32 v40, v72
    v_exp_f32 v41, v73
    v_exp_f32 v42, v74
    v_smfmac_f32_32x32x32_bf16 v[128:143], v[24:27], v[64:71], v62
    v_exp_f32 v43, v75
    v_exp_f32 v44, v76
    v_exp_f32 v45, v77
    v_exp_f32 v46, v78
    v_exp_f32 v47, v79
    s_waitcnt lgkmcnt(0)
    v_mfma_f32_32x32x16_bf16 v[64:79], v[20:23], v[8:11], v[96:111]
    v_exp_f32 v80, v80
    v_exp_f32 v81, v81
    v_exp_f32 v82, v82
    v_exp_f32 v83, v83
    v_exp_f32 v84, v84
    v_exp_f32 v85, v85
    v_smfmac_f32_32x32x32_bf16 v[128:143], v[28:31], v[40:47], v62
    v_exp_f32 v86, v86
    v_exp_f32 v87, v87
    v_exp_f32 v48, v88
    v_exp_f32 v49, v89
    v_exp_f32 v50, v90
    v_smfmac_f32_32x32x32_bf16 v[144:159], v[24:27], v[80:87], v62
    v_exp_f32 v51, v91
    v_exp_f32 v52, v92
    v_exp_f32 v53, v93
    v_exp_f32 v54, v94
    v_exp_f32 v55, v95
    v_mfma_f32_32x32x16_bf16 v[80:95], v[20:23], v[12:15], v[112:127]
    ds_read_b128 v[16:19], v56 offset:4096
    v_exp_f32 v64, v64
    v_exp_f32 v65, v65
    v_exp_f32 v66, v66
    v_exp_f32 v67, v67
    v_exp_f32 v68, v68
    v_exp_f32 v69, v69
    v_smfmac_f32_32x32x32_bf16 v[144:159], v[28:31], v[48:55], v62
    s_mov_b64 exec, s[74:75]
    ds_read_b128 v[24:27], v57 offset:5120
    ds_read_b128 v[28:31], v57 offset:5632
    s_mov_b64 exec, -1
    v_exp_f32 v70, v70
    v_exp_f32 v71, v71
    v_exp_f32 v40, v72
    v_exp_f32 v41, v73
    v_exp_f32 v42, v74
    v_smfmac_f32_32x32x32_bf16 v[128:143], v[32:35], v[64:71], v62
    v_exp_f32 v43, v75
    v_exp_f32 v44, v76
    v_exp_f32 v45, v77
    v_exp_f32 v46, v78
    v_exp_f32 v47, v79
    s_waitcnt lgkmcnt(0)
    v_mfma_f32_32x32x16_bf16 v[64:79], v[16:19], v[8:11], v[96:111]
    v_exp_f32 v80, v80
    v_exp_f32 v81, v81
    v_exp_f32 v82, v82
    v_exp_f32 v83, v83
    v_exp_f32 v84, v84
    v_exp_f32 v85, v85
    v_smfmac_f32_32x32x32_bf16 v[128:143], v[36:39], v[40:47], v62
    v_exp_f32 v86, v86
    v_exp_f32 v87, v87
    v_exp_f32 v48, v88
    v_exp_f32 v49, v89
    v_exp_f32 v50, v90
    v_smfmac_f32_32x32x32_bf16 v[144:159], v[32:35], v[80:87], v62
    v_exp_f32 v51, v91
    v_exp_f32 v52, v92
    v_exp_f32 v53, v93
    v_exp_f32 v54, v94
    v_exp_f32 v55, v95
    s_cmp_lg_u32 s79, 5
    s_cbranch_scc1 L_balt
    s_setprio 0
L_balt:
    v_mfma_f32_32x32x16_bf16 v[80:95], v[16:19], v[12:15], v[112:127]
    ds_read_b128 v[20:23], v56 offset:6144
    v_exp_f32 v64, v64
    v_exp_f32 v65, v65
    v_exp_f32 v66, v66
    v_exp_f32 v67, v67
    v_exp_f32 v68, v68
    v_exp_f32 v69, v69
    v_smfmac_f32_32x32x32_bf16 v[144:159], v[36:39], v[48:55], v62
    s_mov_b64 exec, s[74:75]
    ds_read_b128 v[32:35], v57 offset:7168
    ds_read_b128 v[36:39], v57 offset:7680
    s_mov_b64 exec, -1
    v_exp_f32 v70, v70
    v_exp_f32 v71, v71
    v_exp_f32 v40, v72
    v_exp_f32 v41, v73
    v_exp_f32 v42, v74
    v_smfmac_f32_32x32x32_bf16 v[128:143], v[24:27], v[64:71], v62
    v_exp_f32 v43, v75
    v_exp_f32 v44, v76
    v_exp_f32 v45, v77
    v_exp_f32 v46, v78
    v_exp_f32 v47, v79
    s_waitcnt lgkmcnt(0)
    v_mfma_f32_32x32x16_bf16 v[64:79], v[20:23], v[8:11], v[96:111]
    v_exp_f32 v80, v80
    v_exp_f32 v81, v81
    v_exp_f32 v82, v82
    v_exp_f32 v83, v83
    v_exp_f32 v84, v84
    v_exp_f32 v85, v85
    v_smfmac_f32_32x32x32_bf16 v[128:143], v[28:31], v[40:47], v62
    v_exp_f32 v86, v86
    v_exp_f32 v87, v87
    v_exp_f32 v48, v88
    v_exp_f32 v49, v89
    v_exp_f32 v50, v90
    v_smfmac_f32_32x32x32_bf16 v[144:159], v[24:27], v[80:87], v62
    v_exp_f32 v51, v91
    v_exp_f32 v52, v92
    v_exp_f32 v53, v93
    v_exp_f32 v54, v94
    v_exp_f32 v55, v95
    s_cmp_lg_u32 s79, 4
    s_cbranch_scc1 L_nokw
L_pw_10015:
    ds_read_b64 v[4:5], v60 offset:0
    s_waitcnt lgkmcnt(0)
    v_min_u32 v4, v4, v5
    s_nop 0
    v_readfirstlane_b32 s5, v4
    s_cmp_ge_u32 s5, 8
    s_cbranch_scc1 L_pwd_10016
    s_sleep 1
    s_add_u32 s83, s83, 1
    s_cmp_lt_u32 s83, 200000
    s_cbranch_scc1 L_pw_10015
    s_endpgm
L_pwd_10016:
L_nokw:
    v_mfma_f32_32x32x16_bf16 v[80:95], v[20:23], v[12:15], v[112:127]
    ds_read_b128 v[16:19], v56 offset:16384
    v_exp_f32 v64, v64
    v_exp_f32 v65, v65
    v_exp_f32 v66, v66
    v_exp_f32 v67, v67
    v_exp_f32 v68, v68
    v_exp_f32 v69, v69
    v_smfmac_f32_32x32x32_bf16 v[144:159], v[28:31], v[48:55], v62
    s_mov_b64 exec, s[74:75]
    ds_read_b128 v[24:27], v57 offset:17408
    ds_read_b128 v[28:31], v57 offset:17920
    s_mov_b64 exec, -1
    v_exp_f32 v70, v70
    v_exp_f32 v71, v71
    v_exp_f32 v40, v72
    v_exp_f32 v41, v73
    v_exp_f32 v42, v74
    v_smfmac_f32_32x32x32_bf16 v[128:143], v[32:35], v[64:71], v62
    v_exp_f32 v43, v75
    v_exp_f32 v44, v76
    v_exp_f32 v45, v77
    v_exp_f32 v46, v78
    v_exp_f32 v47, v79
    s_waitcnt lgkmcnt(0)
    v_mfma_f32_32x32x16_bf16 v[64:79], v[16:19], v[8:11], v[96:111]
    v_exp_f32 v80, v80
    v_exp_f32 v81, v81
    v_exp_f32 v82, v82
    v_exp_f32 v83, v83
    v_exp_f32 v84, v84
    v_exp_f32 v85, v85
    v_smfmac_f32_32x32x32_bf16 v[128:143], v[36:39], v[40:47], v62
    v_exp_f32 v86, v86
    v_exp_f32 v87, v87
    v_exp_f32 v48, v88
    v_exp_f32 v49, v89
    v_exp_f32 v50, v90
    v_smfmac_f32_32x32x32_bf16 v[144:159], v[32:35], v[80:87], v62
    v_exp_f32 v51, v91
    v_exp_f32 v52, v92
    v_exp_f32 v53, v93
    v_exp_f32 v54, v94
    v_exp_f32 v55, v95
    v_add_u32 v56, 16384, v56
    v_add_u32 v57, 16384, v57
    s_add_u32 s79, s79, 1
    s_cmp_lg_u32 s79, 4
    s_cbranch_scc1 L_nodead
    s_mov_b64 exec, 1
    v_mov_b32 v4, 1
    ds_add_u32 v59, v4 offset:192
    s_mov_b64 exec, -1
L_nodead:
    s_cmp_lg_u32 s79, 6
    s_cbranch_scc1 L_nodead2
    s_mov_b64 exec, 1
    v_mov_b32 v4, 1
    ds_add_u32 v59, v4 offset:212
    s_mov_b64 exec, -1
L_nodead2:
    s_cmp_lg_u32 s79, 6
    s_cbranch_scc1 L_bal1
    s_setprio 0
L_bal1:
    s_cmp_lt_u32 s79, 7
    s_cbranch_scc1 L_att_loop
    s_setprio 3
    s_lshl_b32 s5, s42, 3
    s_add_u32 s5, s5, s40
    s_lshr_b32 s6, s5, 1
    s_lshl_b32 s6, s6, 7
    s_add_u32 s76, s6, 13828096
    s_lshl_b32 s57, s5, 7
    s_add_u32 s57, s57, 13762560
    v_mov_b32 v60, 0
L_lw_10017:
    ds_read_b32 v160, v59 offset:216
    s_waitcnt lgkmcnt(0)
    v_readfirstlane_b32 s5, v160
    s_cmp_eq_u32 s5, 4
    s_cbranch_scc1 L_lwd_10018
    s_sleep 1
    s_add_u32 s83, s83, 1
    s_cmp_lt_u32 s83, 200000
    s_cbranch_scc1 L_lw_10017
    s_endpgm
L_lwd_10018:
    v_and_b32 v3, 31, v1
    v_lshlrev_b32 v3, 2, v3
    buffer_load_dword v58, v3, s[36:39], s57 offen sc1
    v_add_u32 v4, s53, v2
    v_add_u32 v4, 131072, v4
    v_xor_b32 v5, 2048, v4
    v_lshlrev_b32 v7, 2, v1
    s_lshl_b32 s6, s40, 8
    s_add_u32 s6, s6, 158720
    v_add_u32 v7, s6, v7
    v_xor_b32 v6, 256, v7
    s_lshl_b32 s6, s40, 2
    v_add_u32 v165, s6, v59
    v_xor_b32 v164, 4, v165
    v_mov_b32 v166, 1
    v_mov_b32 v160, s82
    v_mov_b32 v161, s82
    v_mov_b32 v162, s82
    v_mov_b32 v163, s82
    s_lshl_b32 s5, s42, 3
    s_add_u32 s5, s5, s40
    s_lshl_b32 s5, s5, 5
    s_add_u32 s5, s5, s41
    s_lshl_b32 s76, s5, 10
    s_add_u32 s76, s76, 25165824
    s_lshl_b32 s78, s5, 7
    s_add_u32 s78, s78, 14155776
    s_mov_b32 s80, 0x53800000
    s_mov_b32 s81, 0x7f000000
    s_mov_b32 s57, 0xfffeffff
    s_setprio 0
    v_mfma_f32_32x32x16_bf16 v[80:95], v[16:19], v[12:15], v[112:127]
    ds_read_b128 v[20:23], v56 offset:2048
    v_exp_f32 v64, v64
    v_exp_f32 v65, v65
    v_exp_f32 v66, v66
    v_exp_f32 v67, v67
    v_exp_f32 v68, v68
    v_exp_f32 v69, v69
    v_smfmac_f32_32x32x32_bf16 v[144:159], v[36:39], v[48:55], v62
    s_mov_b64 exec, s[74:75]
    ds_read_b128 v[32:35], v57 offset:3072
    ds_read_b128 v[36:39], v57 offset:3584
    s_mov_b64 exec, -1
    v_exp_f32 v70, v70
    v_exp_f32 v71, v71
    v_exp_f32 v40, v72
    v_exp_f32 v41, v73
    v_exp_f32 v42, v74
    v_smfmac_f32_32x32x32_bf16 v[128:143], v[24:27], v[64:71], v62
    v_exp_f32 v43, v75
    v_exp_f32 v44, v76
    v_exp_f32 v45, v77
    v_exp_f32 v46, v78
    v_exp_f32 v47, v79
    s_waitcnt lgkmcnt(0)
    v_mfma_f32_32x32x16_bf16 v[64:79], v[20:23], v[8:11], v[96:111]
    v_exp_f32 v80, v80
    v_exp_f32 v81, v81
    v_exp_f32 v82, v82
    v_exp_f32 v83, v83
    v_exp_f32 v84, v84
    v_exp_f32 v85, v85
    v_smfmac_f32_32x32x32_bf16 v[128:143], v[28:31], v[40:47], v62
    v_exp_f32 v86, v86
    v_exp_f32 v87, v87
    v_exp_f32 v48, v88
    v_exp_f32 v49, v89
    v_exp_f32 v50, v90
    v_smfmac_f32_32x32x32_bf16 v[144:159], v[24:27], v[80:87], v62
    v_exp_f32 v51, v91
    v_exp_f32 v52, v92
    v_exp_f32 v53, v93
    v_exp_f32 v54, v94
    v_exp_f32 v55, v95
    v_mfma_f32_32x32x16_bf16 v[80:95], v[20:23], v[12:15], v[112:127]
    ds_read_b128 v[16:19], v56 offset:4096
    v_exp_f32 v64, v64
    v_exp_f32 v65, v65
    v_exp_f32 v66, v66
    v_exp_f32 v67, v67
    v_exp_f32 v68, v68
    v_exp_f32 v69, v69
    v_smfmac_f32_32x32x32_bf16 v[144:159], v[28:31], v[48:55], v62
    s_mov_b64 exec, s[74:75]
    ds_read_b128 v[24:27], v57 offset:5120
    ds_read_b128 v[28:31], v57 offset:5632
    s_mov_b64 exec, -1
    v_exp_f32 v70, v70
    v_exp_f32 v71, v71
    v_exp_f32 v40, v72
    v_exp_f32 v41, v73
    v_exp_f32 v42, v74
    v_smfmac_f32_32x32x32_bf16 v[128:143], v[32:35], v[64:71], v62
    v_exp_f32 v43, v75
    v_exp_f32 v44, v76
    v_exp_f32 v45, v77
    v_exp_f32 v46, v78
    v_exp_f32 v47, v79
    s_waitcnt lgkmcnt(0)
    v_mfma_f32_32x32x16_bf16 v[64:79], v[16:19], v[8:11], v[96:111]
    v_exp_f32 v80, v80
    v_exp_f32 v81, v81
    v_exp_f32 v82, v82
    v_exp_f32 v83, v83
    v_exp_f32 v84, v84
    v_exp_f32 v85, v85
    v_smfmac_f32_32x32x32_bf16 v[128:143], v[36:39], v[40:47], v62
    v_exp_f32 v86, v86
    v_exp_f32 v87, v87
    v_exp_f32 v48, v88
    v_exp_f32 v49, v89
    v_exp_f32 v50, v90
    v_smfmac_f32_32x32x32_bf16 v[144:159], v[32:35], v[80:87], v62
    v_exp_f32 v51, v91
    v_exp_f32 v52, v92
    v_exp_f32 v53, v93
    v_exp_f32 v54, v94
    v_exp_f32 v55, v95
    v_mfma_f32_32x32x16_bf16 v[80:95], v[16:19], v[12:15], v[112:127]
    ds_read_b128 v[20:23], v56 offset:6144
    v_exp_f32 v64, v64
    v_exp_f32 v65, v65
    v_exp_f32 v66, v66
    v_exp_f32 v67, v67
    v_exp_f32 v68, v68
    v_exp_f32 v69, v69
    v_smfmac_f32_32x32x32_bf16 v[144:159], v[36:39], v[48:55], v62
    s_mov_b64 exec, s[74:75]
    ds_read_b128 v[32:35], v57 offset:7168
    ds_read_b128 v[36:39], v57 offset:7680
    s_mov_b64 exec, -1
    v_exp_f32 v70, v70
    v_exp_f32 v71, v71
    v_exp_f32 v40, v72
    v_exp_f32 v41, v73
    v_exp_f32 v42, v74
    v_smfmac_f32_32x32x32_bf16 v[128:143], v[24:27], v[64:71], v62
    v_exp_f32 v43, v75
    v_exp_f32 v44, v76
    v_exp_f32 v45, v77
    v_exp_f32 v46, v78
    v_exp_f32 v47, v79
    s_waitcnt lgkmcnt(0)
    v_mfma_f32_32x32x16_bf16 v[64:79], v[20:23], v[8:11], v[96:111]
    v_exp_f32 v80, v80
    v_exp_f32 v81, v81
    v_exp_f32 v82, v82
    v_exp_f32 v83, v83
    v_exp_f32 v84, v84
    v_exp_f32 v85, v85
    v_smfmac_f32_32x32x32_bf16 v[128:143], v[28:31], v[40:47], v62
    v_exp_f32 v86, v86
    v_exp_f32 v87, v87
    v_exp_f32 v48, v88
    v_exp_f32 v49, v89
    v_exp_f32 v50, v90
    v_smfmac_f32_32x32x32_bf16 v[144:159], v[24:27], v[80:87], v62
    v_exp_f32 v51, v91
    v_exp_f32 v52, v92
    v_exp_f32 v53, v93
    v_exp_f32 v54, v94
    v_exp_f32 v55, v95
    s_setprio 3
    v_mfma_f32_32x32x16_bf16 v[80:95], v[20:23], v[12:15], v[112:127]
    v_exp_f32 v64, v64
    v_exp_f32 v65, v65
    v_exp_f32 v66, v66
    v_exp_f32 v67, v67
    v_exp_f32 v68, v68
    v_exp_f32 v69, v69
    v_smfmac_f32_32x32x32_bf16 v[144:159], v[28:31], v[48:55], v62
    v_exp_f32 v70, v70
    v_exp_f32 v71, v71
    v_exp_f32 v40, v72
    v_exp_f32 v41, v73
    v_exp_f32 v42, v74
    v_smfmac_f32_32x32x32_bf16 v[128:143], v[32:35], v[64:71], v62
    v_exp_f32 v43, v75
    v_exp_f32 v44, v76
    v_exp_f32 v45, v77
    v_exp_f32 v46, v78
    v_exp_f32 v47, v79
    s_waitcnt lgkmcnt(0)
    v_exp_f32 v80, v80
    v_exp_f32 v81, v81
    v_exp_f32 v82, v82
    v_exp_f32 v83, v83
    v_exp_f32 v84, v84
    v_exp_f32 v85, v85
    v_smfmac_f32_32x32x32_bf16 v[128:143], v[36:39], v[40:47], v62
    v_exp_f32 v86, v86
    v_exp_f32 v87, v87
    v_exp_f32 v48, v88
    v_exp_f32 v49, v89
    v_exp_f32 v50, v90
    v_smfmac_f32_32x32x32_bf16 v[144:159], v[32:35], v[80:87], v62
    v_exp_f32 v51, v91
    v_exp_f32 v52, v92
    v_exp_f32 v53, v93
    v_exp_f32 v54, v94
    v_exp_f32 v55, v95
    s_nop 1
    v_smfmac_f32_32x32x32_bf16 v[144:159], v[36:39], v[48:55], v62
    ds_write_b128 v5, v[128:131]
    ds_write_b128 v5, v[132:135] offset:1024
    ds_write_b32 v6, v136
    ds_write_b32 v164, v166 offset:64
L_pw:
    ds_read_b32 v3, v165 offset:64
    ds_read_b128 v[128:131], v4
    ds_read_b128 v[132:135], v4 offset:1024
    ds_read_b32 v136, v7
    s_waitcnt lgkmcnt(0)
    v_readfirstlane_b32 s5, v3
    s_cmp_eq_u32 s5, 1
    s_cbranch_scc1 L_pwd
    s_sleep 0
    s_add_u32 s83, s83, 1
    s_cmp_lt_u32 s83, 200000
    s_cbranch_scc1 L_pw
    s_endpgm
L_pwd:
    v_add_f32 v136, v136, v152
    v_add_f32 v128, v128, v144
    v_add_f32 v129, v129, v145
    v_add_f32 v130, v130, v146
    v_add_f32 v131, v131, v147
    v_add_f32 v132, v132, v148
    v_add_f32 v133, v133, v149
    v_add_f32 v134, v134, v150
    v_add_f32 v135, v135, v151
L_att_check:
    v_mov_b32 v3, v136
    v_add_f32 v4, |v128|, |v129|
    v_add_f32 v5, |v130|, |v131|
    v_permlane32_swap_b32 v136, v3
    v_add_f32 v6, |v132|, |v133|
    v_add_f32 v7, |v134|, |v135|
    v_rcp_f32 v3, v136
    v_add_f32 v4, v4, v5
    v_add_f32 v6, v6, v7
    v_add_f32 v4, v4, v6
    v_cmp_nle_f32 vcc, v136, s80
    v_cmp_nle_f32 s[48:49], v4, s81
    s_cmp_eq_u32 s77, 3
    s_cbranch_scc1 L_att_fin
    s_or_b64 vcc, vcc, s[48:49]
    s_cbranch_scc0 L_att_fin
    s_mov_b32 s77, 3
    s_lshl_b32 s56, s41, 17
    s_add_u32 s56, s56, 2097152
    v_mov_b32 v56, v2
    v_mov_b32 v3, 0xff800000
    s_mov_b32 s79, 0
L_fb_max:
    buffer_load_dwordx4 v[16:19], v56, s[36:39], s56 offen sc1
    s_waitcnt vmcnt(0)
    v_mfma_f32_32x32x16_bf16 v[64:79], v[16:19], v[12:15], 0
    v_add_u32 v56, 2048, v56
    s_nop 7
    s_nop 7
    s_nop 3
    v_max3_f32 v3, v3, v64, v65
    v_max3_f32 v3, v3, v66, v67
    v_max3_f32 v3, v3, v68, v69
    v_max3_f32 v3, v3, v70, v71
    v_max3_f32 v3, v3, v72, v73
    v_max3_f32 v3, v3, v74, v75
    v_max3_f32 v3, v3, v76, v77
    v_max3_f32 v3, v3, v78, v79
    s_add_u32 s79, s79, 1
    s_cmp_lt_u32 s79, 64
    s_cbranch_scc1 L_fb_max
    v_mov_b32 v4, v3
    s_nop 1
    v_permlane32_swap_b32 v3, v4
    s_nop 1
    v_max_f32 v3, v3, v4
    v_sub_f32 v96, 0, v3
    v_mov_b32 v128, 0
    v_sub_f32 v97, 0, v3
    v_mov_b32 v129, 0
    v_sub_f32 v98, 0, v3
    v_mov_b32 v130, 0
    v_sub_f32 v99, 0, v3
    v_mov_b32 v131, 0
    v_sub_f32 v100, 0, v3
    v_mov_b32 v132, 0
    v_sub_f32 v101, 0, v3
    v_mov_b32 v133, 0
    v_sub_f32 v102, 0, v3
    v_mov_b32 v134, 0
    v_sub_f32 v103, 0, v3
    v_mov_b32 v135, 0
    v_sub_f32 v104, 0, v3
    v_mov_b32 v136, 0
    v_sub_f32 v105, 0, v3
    v_mov_b32 v137, 0
    v_sub_f32 v106, 0, v3
    v_mov_b32 v138, 0
    v_sub_f32 v107, 0, v3
    v_mov_b32 v139, 0
    v_sub_f32 v108, 0, v3
    v_mov_b32 v140, 0
    v_sub_f32 v109, 0, v3
    v_mov_b32 v141, 0
    v_sub_f32 v110, 0, v3
    v_mov_b32 v142, 0
    v_sub_f32 v111, 0, v3
    v_mov_b32 v143, 0
    v_mov_b32 v56, v2
    v_lshrrev_b32 v4, 5, v1
    v_and_b32 v5, 15, v1
    v_lshlrev_b32 v5, 4, v5
    v_lshl_add_u32 v57, v4, 8, v5
    s_mov_b32 s79, 0
L_fb_loop:
    buffer_load_dwordx4 v[16:19], v56, s[36:39], s56 offen sc1
    s_mov_b64 exec, s[74:75]
    buffer_load_dwordx4 v[24:27], v57, s[36:39], s56 offen offset:1024 sc1
    buffer_load_dwordx4 v[28:31], v57, s[36:39], s56 offen offset:1536 sc1
    s_mov_b64 exec, -1
    s_waitcnt vmcnt(0)
    v_mfma_f32_32x32x16_bf16 v[64:79], v[16:19], v[12:15], v[96:111]
    v_add_u32 v56, 2048, v56
    v_add_u32 v57, 2048, v57
    s_nop 7
    s_nop 7
    v_exp_f32 v64, v64
    v_exp_f32 v65, v65
    v_exp_f32 v66, v66
    v_exp_f32 v67, v67
    v_exp_f32 v68, v68
    v_exp_f32 v69, v69
    v_exp_f32 v70, v70
    v_exp_f32 v71, v71
    v_exp_f32 v72, v72
    v_exp_f32 v73, v73
    v_exp_f32 v74, v74
    v_exp_f32 v75, v75
    v_exp_f32 v76, v76
    v_exp_f32 v77, v77
    v_exp_f32 v78, v78
    v_exp_f32 v79, v79
    s_nop 3
    v_smfmac_f32_32x32x32_bf16 v[128:143], v[24:27], v[64:71], v62
    v_smfmac_f32_32x32x32_bf16 v[128:143], v[28:31], v[72:79], v62
    s_add_u32 s79, s79, 1
    s_cmp_lt_u32 s79, 64
    s_cbranch_scc1 L_fb_loop
    s_nop 7
    s_nop 7
    s_branch L_att_check
L_att_fin:
    s_waitcnt vmcnt(0)
    v_mul_f32 v3, v3, v58
    v_mul_f32 v128, v128, v3
    v_mul_f32 v129, v129, v3
    v_mul_f32 v130, v130, v3
    v_mul_f32 v131, v131, v3
    v_mul_f32 v132, v132, v3
    v_mul_f32 v133, v133, v3
    v_mul_f32 v134, v134, v3
    v_mul_f32 v135, v135, v3
    v_cvt_pk_bf16_f32 v40, v128, v129
    v_cvt_pk_bf16_f32 v41, v130, v131
    v_cvt_pk_bf16_f32 v42, v132, v133
    v_cvt_pk_bf16_f32 v43, v134, v135
    v_min_u32 v40, s57, v40
    v_min_u32 v41, s57, v41
    v_min_u32 v42, s57, v42
    v_min_u32 v43, s57, v43
    buffer_store_dwordx4 v[40:43], v2, s[36:39], s76 offen sc1
    s_cmp_lg_u32 s58, 0
    s_cbranch_scc1 L_nofl3
    s_mov_b64 exec, 0xff
    buffer_store_dwordx4 v[160:163], v2, s[36:39], s78 offen sc1
    s_mov_b64 exec, -1
L_nofl3:
    s_or_b32 s5, s2, s40
    s_cmp_lg_u32 s5, 0
    s_cbranch_scc1 L_nobump
    v_lshlrev_b32 v3, 7, v1
    s_mov_b32 s58, 13697024
L_poll_10019:
    buffer_load_dword v9, v3, s[36:39], s58 offen offset:0 sc1
    s_waitcnt vmcnt(0)
    v_xor_b32 v9, s82, v9
    v_cmp_ne_u32 vcc, 0, v9
    s_cmp_eq_u64 vcc, 0
    s_cbranch_scc1 L_pdone_10020
    s_sleep 12
    s_add_u32 s83, s83, 1
    s_cmp_lt_u32 s83, 200000
    s_cbranch_scc1 L_poll_10019
    s_endpgm
L_pdone_10020:
    s_mov_b32 s58, 13705216
L_poll_10021:
    buffer_load_dword v9, v3, s[36:39], s58 offen offset:0 sc1
    s_waitcnt vmcnt(0)
    v_xor_b32 v9, s82, v9
    v_cmp_ne_u32 vcc, 0, v9
    s_cmp_eq_u64 vcc, 0
    s_cbranch_scc1 L_pdone_10022
    s_sleep 12
    s_add_u32 s83, s83, 1
    s_cmp_lt_u32 s83, 200000
    s_cbranch_scc1 L_poll_10021
    s_endpgm
L_pdone_10022:
    s_mov_b32 s58, 13713408
L_poll_10023:
    buffer_load_dword v9, v3, s[36:39], s58 offen offset:0 sc1
    s_waitcnt vmcnt(0)
    v_xor_b32 v9, s82, v9
    v_cmp_ne_u32 vcc, 0, v9
    s_cmp_eq_u64 vcc, 0
    s_cbranch_scc1 L_pdone_10024
    s_sleep 12
    s_add_u32 s83, s83, 1
    s_cmp_lt_u32 s83, 200000
    s_cbranch_scc1 L_poll_10023
    s_endpgm
L_pdone_10024:
    s_mov_b32 s58, 13721600
L_poll_10025:
    buffer_load_dword v9, v3, s[36:39], s58 offen offset:0 sc1
    s_waitcnt vmcnt(0)
    v_xor_b32 v9, s82, v9
    v_cmp_ne_u32 vcc, 0, v9
    s_cmp_eq_u64 vcc, 0
    s_cbranch_scc1 L_pdone_10026
    s_sleep 12
    s_add_u32 s83, s83, 1
    s_cmp_lt_u32 s83, 200000
    s_cbranch_scc1 L_poll_10025
    s_endpgm
L_pdone_10026:
    s_mov_b64 exec, 1
    s_add_u32 s5, s84, 1
    v_mov_b32 v9, s5
    buffer_store_dword v9, v2, s[36:39], 0 offen offset:0 sc1
    s_mov_b64 exec, -1
L_nobump:
    s_andn2_b32 s5, s40, 2
    s_cmp_lg_u32 s5, 1
    s_cbranch_scc1 L_noap
    s_lshl_b32 s56, s41, 13
    s_lshr_b32 s5, s40, 1
    s_lshl_b32 s6, s5, 11
    s_add_u32 s56, s56, s6
    s_add_u32 s56, s56, 14155776
    s_lshl_b32 s5, s5, 2
    v_add_u32 v14, s5, v59
    v_lshlrev_b32 v7, 7, v1
    s_mov_b32 s59, 0
L_ap:
    s_andn2_b32 s5, 0x1111, s59
    s_mul_i32 s58, s5, 15
    s_mov_b32 exec_lo, s58
    s_mov_b32 exec_hi, 0
    buffer_load_dword v3, v7, s[36:39], s56 offen sc1
    s_waitcnt vmcnt(0)
    v_cmp_ne_u32 vcc, s82, v3
    s_mov_b64 exec, -1
    s_lshr_b32 s5, vcc_lo, 1
    s_or_b32 s5, s5, vcc_lo
    s_lshr_b32 s6, s5, 2
    s_or_b32 s5, s5, s6
    s_andn2_b32 s59, 0x1111, s5
    s_or_b32 s5, s59, 2
    v_mov_b32 v4, s5
    s_mov_b64 exec, 1
    ds_or_b32 v14, v4 offset:200
    s_mov_b64 exec, -1
    s_cmp_eq_u32 s59, 0x1111
    s_cbranch_scc1 L_noap
    s_sleep 1
    s_add_u32 s83, s83, 1
    s_cmp_lt_u32 s83, 200000
    s_cbranch_scc1 L_ap
    s_endpgm
L_noap:
    s_waitcnt lgkmcnt(0)
    s_endpgm
L_aux1:
    s_and_b32 s5, s4, 3
    s_lshl_b32 s5, s5, 1
    s_add_u32 s73, s5, s42
    s_lshr_b32 s5, s87, 1
    s_mul_i32 s76, s5, 7
    s_add_u32 s76, s76, s43
    s_and_b32 s5, s87, 1
    s_lshl_b32 s6, s5, 2
    s_add_u32 s76, s76, s6
    s_mov_b32 s85, 0
    s_add_u32 s6, s6, s43
    s_cmp_lg_u32 s6, 7
    s_cbranch_scc1 L_role
    s_mov_b32 s85, 2
    s_cmp_lg_u32 s87, 1
    s_cbranch_scc1 L_role
    s_mov_b32 s85, 1
L_role:
    s_mul_i32 s54, s86, 229376
    s_lshl_b32 s5, s76, 12
    s_add_u32 s54, s54, s5
    s_add_u32 s54, s54, 16777216
    s_add_u32 s55, s54, 114688
    s_lshl_b32 s76, s76, 7
    s_waitcnt lgkmcnt(0)
    s_mul_i32 s82, s84, 0x9e3779b1
    s_add_u32 s82, s82, 0x7f4a7c15
    v_and_b32 v3, 31, v1
    v_lshrrev_b32 v4, 5, v1
    v_bfe_u32 v5, v1, 1, 3
    v_xor_b32 v5, v5, v4
    v_lshlrev_b32 v3, 7, v3
    s_and_b32 s5, s40, 1
    s_lshl_b32 s5, s5, 12
    s_add_u32 s5, s5, 49152
    v_add_u32 v3, s5, v3
    v_xor_b32 v7, 0, v5
    v_lshl_add_u32 v8, v7, 4, v3
    v_xor_b32 v7, 2, v5
    v_lshl_add_u32 v9, v7, 4, v3
    v_xor_b32 v7, 4, v5
    v_lshl_add_u32 v10, v7, 4, v3
    v_xor_b32 v7, 6, v5
    v_lshl_add_u32 v11, v7, 4, v3
    v_bfe_u32 v7, v1, 2, 2
    v_lshl_add_u32 v7, v4, 3, v7
    v_lshlrev_b32 v12, 7, v7
    v_bfe_u32 v5, v1, 4, 1
    v_bfe_u32 v6, v1, 1, 1
    v_lshl_add_u32 v6, v5, 1, v6
    v_bfe_u32 v5, v1, 3, 1
    s_lshr_b32 s5, s40, 1
    s_and_b32 s5, s5, 1
    v_xor_b32 v5, s5, v5
    v_lshl_add_u32 v6, v5, 2, v6
    v_lshl_add_u32 v12, v6, 4, v12
    v_and_b32 v5, 1, v1
    v_lshl_add_u32 v12, v5, 3, v12
    s_lshr_b32 s5, s40, 2
    s_lshl_b32 s5, s5, 13
    v_add_u32 v12, s5, v12
    v_add_u32 v62, 114688, v12
    v_mov_b32 v13, 157696
    s_setprio 0
    s_waitcnt vmcnt(6)
    s_barrier
    s_add_u32 s5, s49, 4
    s_and_b32 s5, s5, 7
    s_lshl_b32 s5, s5, 7
    s_add_u32 m0, s79, 81920
    s_add_u32 s50, s5, s78
    buffer_load_dwordx4 v14, s[28:31], s50 offen lds
    s_add_u32 m0, s79, 82944
    s_nop 0
    buffer_load_dwordx4 v15, s[28:31], s50 offen lds
    s_add_u32 s5, s49, 5
    s_and_b32 s5, s5, 7
    s_lshl_b32 s5, s5, 7
    s_add_u32 m0, s79, 90112
    s_add_u32 s50, s5, s78
    buffer_load_dwordx4 v14, s[28:31], s50 offen lds
    s_add_u32 m0, s79, 91136
    s_nop 0
    buffer_load_dwordx4 v15, s[28:31], s50 offen lds
    ds_read_b128 v[80:83], v8 offset:0
    ds_read_b64_tr_b16 v[96:97], v62 offset:24576
    ds_read_b64_tr_b16 v[98:99], v62 offset:25088
    ds_read_b128 v[84:87], v9 offset:0
    ds_read_b64_tr_b16 v[100:101], v62 offset:26624
    ds_read_b64_tr_b16 v[102:103], v62 offset:27136
    ds_read_b128 v[88:91], v10 offset:0
    ds_read_b64_tr_b16 v[104:105], v62 offset:28672
    ds_read_b64_tr_b16 v[106:107], v62 offset:29184
    ds_read_b128 v[92:95], v11 offset:0
    ds_read_b64_tr_b16 v[108:109], v62 offset:30720
    ds_read_b64_tr_b16 v[110:111], v62 offset:31232
    s_waitcnt lgkmcnt(0)
    s_waitcnt vmcnt(8)
    s_barrier
    s_add_u32 s5, s49, 6
    s_and_b32 s5, s5, 7
    s_lshl_b32 s5, s5, 7
    s_add_u32 m0, s79, 98304
    s_add_u32 s50, s5, s78
    buffer_load_dwordx4 v14, s[28:31], s50 offen lds
    s_add_u32 m0, s79, 99328
    s_nop 0
    buffer_load_dwordx4 v15, s[28:31], s50 offen lds
    s_add_u32 s5, s49, 7
    s_and_b32 s5, s5, 7
    s_lshl_b32 s5, s5, 7
    s_add_u32 m0, s79, 106496
    s_add_u32 s50, s5, s78
    buffer_load_dwordx4 v14, s[28:31], s50 offen lds
    s_add_u32 m0, s79, 107520
    s_nop 0
    buffer_load_dwordx4 v15, s[28:31], s50 offen lds
    ds_read_b128 v[112:115], v8 offset:8192
    ds_read_b64_tr_b16 v[128:129], v62 offset:0
    ds_read_b64_tr_b16 v[130:131], v62 offset:512
    ds_read_b128 v[116:119], v9 offset:8192
    ds_read_b64_tr_b16 v[132:133], v62 offset:2048
    ds_read_b64_tr_b16 v[134:135], v62 offset:2560
    ds_read_b128 v[120:123], v10 offset:8192
    ds_read_b64_tr_b16 v[136:137], v62 offset:4096
    ds_read_b64_tr_b16 v[138:139], v62 offset:4608
    ds_read_b128 v[124:127], v11 offset:8192
    ds_read_b64_tr_b16 v[140:141], v62 offset:6144
    ds_read_b64_tr_b16 v[142:143], v62 offset:6656
    v_mfma_f32_32x32x16_bf16 v[64:79], v[80:83], v[96:99], 0
    v_mfma_f32_32x32x16_bf16 v[64:79], v[84:87], v[100:103], v[64:79]
    v_mfma_f32_32x32x16_bf16 v[64:79], v[88:91], v[104:107], v[64:79]
    v_mfma_f32_32x32x16_bf16 v[64:79], v[92:95], v[108:111], v[64:79]
    s_waitcnt lgkmcnt(0)
    s_waitcnt vmcnt(10)
    s_barrier
    ds_read_b128 v[80:83], v8 offset:16384
    ds_read_b64_tr_b16 v[96:97], v12 offset:24576
    ds_read_b64_tr_b16 v[98:99], v12 offset:25088
    ds_read_b128 v[84:87], v9 offset:16384
    ds_read_b64_tr_b16 v[100:101], v12 offset:26624
    ds_read_b64_tr_b16 v[102:103], v12 offset:27136
    ds_read_b128 v[88:91], v10 offset:16384
    ds_read_b64_tr_b16 v[104:105], v12 offset:28672
    ds_read_b64_tr_b16 v[106:107], v12 offset:29184
    ds_read_b128 v[92:95], v11 offset:16384
    ds_read_b64_tr_b16 v[108:109], v12 offset:30720
    ds_read_b64_tr_b16 v[110:111], v12 offset:31232
    v_mfma_f32_32x32x16_bf16 v[64:79], v[112:115], v[128:131], v[64:79]
    v_mfma_f32_32x32x16_bf16 v[64:79], v[116:119], v[132:135], v[64:79]
    v_mfma_f32_32x32x16_bf16 v[64:79], v[120:123], v[136:139], v[64:79]
    v_mfma_f32_32x32x16_bf16 v[64:79], v[124:127], v[140:143], v[64:79]
    s_waitcnt lgkmcnt(0)
    s_waitcnt vmcnt(8)
    s_barrier
    ds_read_b128 v[112:115], v8 offset:24576
    ds_read_b64_tr_b16 v[128:129], v12 offset:0
    ds_read_b64_tr_b16 v[130:131], v12 offset:512
    ds_read_b128 v[116:119], v9 offset:24576
    ds_read_b64_tr_b16 v[132:133], v12 offset:2048
    ds_read_b64_tr_b16 v[134:135], v12 offset:2560
    ds_read_b128 v[120:123], v10 offset:24576
    ds_read_b64_tr_b16 v[136:137], v12 offset:4096
    ds_read_b64_tr_b16 v[138:139], v12 offset:4608
    ds_read_b128 v[124:127], v11 offset:24576
    ds_read_b64_tr_b16 v[140:141], v12 offset:6144
    ds_read_b64_tr_b16 v[142:143], v12 offset:6656
    v_mfma_f32_32x32x16_bf16 v[64:79], v[80:83], v[96:99], v[64:79]
    v_mfma_f32_32x32x16_bf16 v[64:79], v[84:87], v[100:103], v[64:79]
    v_mfma_f32_32x32x16_bf16 v[64:79], v[88:91], v[104:107], v[64:79]
    v_mfma_f32_32x32x16_bf16 v[64:79], v[92:95], v[108:111], v[64:79]
    s_waitcnt lgkmcnt(0)
    s_waitcnt vmcnt(0)
    s_barrier
    s_mov_b32 s32, s16
    s_and_b32 s33, s17, 0xffff
    s_mov_b32 s34, 0x1c0000
    s_mov_b32 s35, 0x20000
    v_lshrrev_b32 v3, 3, v1
    v_mul_u32_u24 v4, 3584, v3
    v_bfe_u32 v5, v1, 4, 1
    v_lshlrev_b32 v5, 2, v5
    v_and_b32 v6, 7, v1
    v_xor_b32 v6, v6, v5
    v_lshl_add_u32 v14, v6, 4, v4
    v_add_u32 v15, 28672, v14
    ds_read_b128 v[80:83], v8 offset:32768
    ds_read_b64_tr_b16 v[96:97], v62 offset:24576
    ds_read_b64_tr_b16 v[98:99], v62 offset:25088
    ds_read_b128 v[84:87], v9 offset:32768
    ds_read_b64_tr_b16 v[100:101], v62 offset:26624
    ds_read_b64_tr_b16 v[102:103], v62 offset:27136
    ds_read_b128 v[88:91], v10 offset:32768
    ds_read_b64_tr_b16 v[104:105], v62 offset:28672
    ds_read_b64_tr_b16 v[106:107], v62 offset:29184
    ds_read_b128 v[92:95], v11 offset:32768
    ds_read_b64_tr_b16 v[108:109], v62 offset:30720
    ds_read_b64_tr_b16 v[110:111], v62 offset:31232
    v_mfma_f32_32x32x16_bf16 v[64:79], v[112:115], v[128:131], v[64:79]
    v_mfma_f32_32x32x16_bf16 v[64:79], v[116:119], v[132:135], v[64:79]
    v_mfma_f32_32x32x16_bf16 v[64:79], v[120:123], v[136:139], v[64:79]
    v_mfma_f32_32x32x16_bf16 v[64:79], v[124:127], v[140:143], v[64:79]
    s_waitcnt lgkmcnt(0)
    s_barrier
    s_cmp_lg_u32 s85, 0
    s_cbranch_scc1 L_w1s_20001
    s_add_u32 s5, s49, 0
    s_and_b32 s5, s5, 7
    s_mul_i32 s50, s5, 229376
    s_add_u32 s50, s50, s76
    s_add_u32 m0, s79, 139264
    s_add_u32 s51, s50, 0
    buffer_load_dwordx4 v14, s[32:35], s51 offen lds
    s_add_u32 m0, s79, 140288
    s_nop 0
    buffer_load_dwordx4 v15, s[32:35], s51 offen lds
    s_add_u32 m0, s79, 147456
    s_add_u32 s51, s50, 57344
    buffer_load_dwordx4 v14, s[32:35], s51 offen lds
    s_add_u32 m0, s79, 148480
    s_nop 0
    buffer_load_dwordx4 v15, s[32:35], s51 offen lds
L_w1s_20001:
    s_mov_b32 s60, s20
    s_and_b32 s61, s21, 0xffff
    s_mov_b32 s62, 0x400
    s_mov_b32 s63, 0x20000
    s_cmp_lg_u32 s85, 1
    s_cbranch_scc1 L_nogd
    s_lshl_b32 s5, s49, 3
    v_add_u32 v3, s5, v1
    v_and_b32 v3, 63, v3
    v_lshlrev_b32 v3, 4, v3
    s_add_u32 m0, s79, 139264
    s_nop 0
    buffer_load_dwordx4 v3, s[60:63], 0 offen lds
L_nogd:
    v_mov_b32 v3, 0
    v_lshlrev_b32 v4, 2, v1
    v_add_u32 v4, 157696, v4
    ds_write_b32 v4, v3
    ds_read_b128 v[112:115], v8 offset:40960
    ds_read_b64_tr_b16 v[128:129], v62 offset:0
    ds_read_b64_tr_b16 v[130:131], v62 offset:512
    ds_read_b128 v[116:119], v9 offset:40960
    ds_read_b64_tr_b16 v[132:133], v62 offset:2048
    ds_read_b64_tr_b16 v[134:135], v62 offset:2560
    ds_read_b128 v[120:123], v10 offset:40960
    ds_read_b64_tr_b16 v[136:137], v62 offset:4096
    ds_read_b64_tr_b16 v[138:139], v62 offset:4608
    ds_read_b128 v[124:127], v11 offset:40960
    ds_read_b64_tr_b16 v[140:141], v62 offset:6144
    ds_read_b64_tr_b16 v[142:143], v62 offset:6656
    v_mfma_f32_32x32x16_bf16 v[64:79], v[80:83], v[96:99], v[64:79]
    v_mfma_f32_32x32x16_bf16 v[64:79], v[84:87], v[100:103], v[64:79]
    v_mfma_f32_32x32x16_bf16 v[64:79], v[88:91], v[104:107], v[64:79]
    v_mfma_f32_32x32x16_bf16 v[64:79], v[92:95], v[108:111], v[64:79]
    s_waitcnt lgkmcnt(0)
    s_barrier
    s_cmp_lg_u32 s85, 0
    s_cbranch_scc1 L_w1s_20002
    s_add_u32 m0, s79, 114688
    s_add_u32 s51, s50, 114688
    buffer_load_dwordx4 v14, s[32:35], s51 offen lds
    s_add_u32 m0, s79, 115712
    s_nop 0
    buffer_load_dwordx4 v15, s[32:35], s51 offen lds
    s_add_u32 m0, s79, 122880
    s_add_u32 s51, s50, 172032
    buffer_load_dwordx4 v14, s[32:35], s51 offen lds
    s_add_u32 m0, s79, 123904
    s_nop 0
    buffer_load_dwordx4 v15, s[32:35], s51 offen lds
    s_add_u32 s5, s49, 1
    s_and_b32 s5, s5, 7
    s_mul_i32 s50, s5, 229376
    s_add_u32 s50, s50, s76
    s_add_u32 m0, s79, 131072
    s_add_u32 s51, s50, 0
    buffer_load_dwordx4 v14, s[32:35], s51 offen lds
    s_add_u32 m0, s79, 132096
    s_nop 0
    buffer_load_dwordx4 v15, s[32:35], s51 offen lds
L_w1s_20002:
    s_add_u32 s5, s79, 24576
    v_add_u32 v3, s5, v2
    v_and_b32 v160, 0x7ff, v12
    s_and_b32 s5, s43, 2
    s_lshl_b32 s5, s5, 5
    v_xor_b32 v160, s5, v160
    s_add_u32 s5, s79, 114688
    v_add_u32 v160, s5, v160
    v_xor_b32 v161, 64, v160
    v_subrev_u32 v162, 114688, v160
    v_subrev_u32 v163, 114688, v161
    v_and_b32 v4, 31, v1
    v_lshlrev_b32 v165, 7, v4
    s_lshl_b32 s5, s43, 2
    v_add_u32 v166, s5, v13
    s_lshl_b32 s77, s3, 12
    s_add_u32 s77, s77, 13893632
    ds_read_b128 v[80:83], v8 offset:49152
    ds_read_b64_tr_b16 v[96:97], v12 offset:24576
    ds_read_b64_tr_b16 v[98:99], v12 offset:25088
    ds_read_b128 v[84:87], v9 offset:49152
    ds_read_b64_tr_b16 v[100:101], v12 offset:26624
    ds_read_b64_tr_b16 v[102:103], v12 offset:27136
    ds_read_b128 v[88:91], v10 offset:49152
    ds_read_b64_tr_b16 v[104:105], v12 offset:28672
    ds_read_b64_tr_b16 v[106:107], v12 offset:29184
    ds_read_b128 v[92:95], v11 offset:49152
    ds_read_b64_tr_b16 v[108:109], v12 offset:30720
    ds_read_b64_tr_b16 v[110:111], v12 offset:31232
    v_mfma_f32_32x32x16_bf16 v[64:79], v[112:115], v[128:131], v[64:79]
    v_mfma_f32_32x32x16_bf16 v[64:79], v[116:119], v[132:135], v[64:79]
    v_mfma_f32_32x32x16_bf16 v[64:79], v[120:123], v[136:139], v[64:79]
    v_mfma_f32_32x32x16_bf16 v[64:79], v[124:127], v[140:143], v[64:79]
    s_waitcnt lgkmcnt(0)
    s_barrier
    s_cmp_lg_u32 s85, 0
    s_cbranch_scc1 L_w1s_20003
    s_add_u32 m0, s79, 32768
    s_add_u32 s51, s50, 57344
    buffer_load_dwordx4 v14, s[32:35], s51 offen lds
    s_add_u32 m0, s79, 33792
    s_nop 0
    buffer_load_dwordx4 v15, s[32:35], s51 offen lds
    s_add_u32 m0, s79, 40960
    s_add_u32 s51, s50, 114688
    buffer_load_dwordx4 v14, s[32:35], s51 offen lds
    s_add_u32 m0, s79, 41984
    s_nop 0
    buffer_load_dwordx4 v15, s[32:35], s51 offen lds
L_w1s_20003:
    s_setprio 0
    ds_read_b128 v[112:115], v8 offset:57344
    ds_read_b64_tr_b16 v[128:129], v12 offset:0
    ds_read_b64_tr_b16 v[130:131], v12 offset:512
    ds_read_b128 v[116:119], v9 offset:57344
    ds_read_b64_tr_b16 v[132:133], v12 offset:2048
    ds_read_b64_tr_b16 v[134:135], v12 offset:2560
    ds_read_b128 v[120:123], v10 offset:57344
    ds_read_b64_tr_b16 v[136:137], v12 offset:4096
    ds_read_b64_tr_b16 v[138:139], v12 offset:4608
    ds_read_b128 v[124:127], v11 offset:57344
    ds_read_b64_tr_b16 v[140:141], v12 offset:6144
    ds_read_b64_tr_b16 v[142:143], v12 offset:6656
    v_mfma_f32_32x32x16_bf16 v[64:79], v[80:83], v[96:99], v[64:79]
    v_mfma_f32_32x32x16_bf16 v[64:79], v[84:87], v[100:103], v[64:79]
    v_mfma_f32_32x32x16_bf16 v[64:79], v[88:91], v[104:107], v[64:79]
    v_mfma_f32_32x32x16_bf16 v[64:79], v[92:95], v[108:111], v[64:79]
    s_waitcnt lgkmcnt(0)
    v_mfma_f32_32x32x16_bf16 v[64:79], v[112:115], v[128:131], v[64:79]
    v_mfma_f32_32x32x16_bf16 v[64:79], v[116:119], v[132:135], v[64:79]
    v_mfma_f32_32x32x16_bf16 v[64:79], v[120:123], v[136:139], v[64:79]
    v_mfma_f32_32x32x16_bf16 v[64:79], v[124:127], v[140:143], v[64:79]
    s_movk_i32 s5, 0xefff
    v_and_b32 v8, s5, v8
    v_and_b32 v9, s5, v9
    v_and_b32 v10, s5, v10
    v_and_b32 v11, s5, v11
    s_nop 7
    s_nop 5
    v_cvt_pk_bf16_f32 v80, v64, v65
    v_cvt_pk_bf16_f32 v81, v66, v67
    v_cvt_pk_bf16_f32 v82, v68, v69
    v_cvt_pk_bf16_f32 v83, v70, v71
    v_cvt_pk_bf16_f32 v84, v72, v73
    v_cvt_pk_bf16_f32 v85, v74, v75
    v_cvt_pk_bf16_f32 v86, v76, v77
    v_cvt_pk_bf16_f32 v87, v78, v79
    s_nop 1
    v_permlane32_swap_b32 v80, v82
    v_permlane32_swap_b32 v81, v83
    v_permlane32_swap_b32 v84, v86
    v_permlane32_swap_b32 v85, v87
    s_nop 1
    ds_write_b128 v3, v[80:83]
    ds_write_b128 v3, v[84:87] offset:1024
    s_waitcnt lgkmcnt(0)
    s_barrier
    s_setprio 2
    s_cmp_eq_u32 s85, 1
    s_cbranch_scc1 L_f1g
    s_cmp_eq_u32 s85, 2
    s_cbranch_scc1 L_f1n
    s_waitcnt vmcnt(12)
    ds_read_b64_tr_b16 v[80:81], v160 offset:24576
    ds_read_b64_tr_b16 v[82:83], v160 offset:25088
    ds_read_b128 v[88:91], v8 offset:0
    ds_read_b128 v[92:95], v8 offset:4096
    ds_read_b64_tr_b16 v[84:85], v161 offset:24576
    ds_read_b64_tr_b16 v[86:87], v161 offset:25088
    s_waitcnt lgkmcnt(0)
    v_mfma_f32_32x32x16_bf16 v[16:31], v[80:83], v[88:91], 0
    s_waitcnt vmcnt(10)
    ds_read_b64_tr_b16 v[96:97], v160 offset:32768
    ds_read_b64_tr_b16 v[98:99], v160 offset:33280
    ds_read_b128 v[104:107], v9 offset:0
    v_mfma_f32_32x32x16_bf16 v[32:47], v[80:83], v[92:95], 0
    ds_read_b128 v[108:111], v9 offset:4096
    ds_read_b64_tr_b16 v[100:101], v161 offset:32768
    ds_read_b64_tr_b16 v[102:103], v161 offset:33280
    v_mfma_f32_32x32x16_bf16 v[48:63], v[84:87], v[88:91], 0
    s_add_u32 m0, s79, 139264
    s_add_u32 s51, s50, 172032
    buffer_load_dwordx4 v14, s[32:35], s51 offen lds
    v_mfma_f32_32x32x16_bf16 v[64:79], v[84:87], v[92:95], 0
    s_add_u32 m0, s79, 140288
    s_nop 0
    buffer_load_dwordx4 v15, s[32:35], s51 offen lds
    s_waitcnt lgkmcnt(0)
    v_mfma_f32_32x32x16_bf16 v[16:31], v[96:99], v[104:107], v[16:31]
    s_waitcnt vmcnt(10)
    ds_read_b64_tr_b16 v[80:81], v160 offset:0
    ds_read_b64_tr_b16 v[82:83], v160 offset:512
    ds_read_b128 v[88:91], v10 offset:0
    v_mfma_f32_32x32x16_bf16 v[32:47], v[96:99], v[108:111], v[32:47]
    ds_read_b128 v[92:95], v10 offset:4096
    ds_read_b64_tr_b16 v[84:85], v161 offset:0
    ds_read_b64_tr_b16 v[86:87], v161 offset:512
    v_mfma_f32_32x32x16_bf16 v[48:63], v[100:103], v[104:107], v[48:63]
    s_add_u32 s5, s49, 2
    s_and_b32 s5, s5, 7
    s_mul_i32 s50, s5, 229376
    s_add_u32 s50, s50, s76
    s_add_u32 m0, s79, 147456
    s_add_u32 s51, s50, 0
    buffer_load_dwordx4 v14, s[32:35], s51 offen lds
    v_mfma_f32_32x32x16_bf16 v[64:79], v[100:103], v[108:111], v[64:79]
    s_add_u32 m0, s79, 148480
    s_nop 0
    buffer_load_dwordx4 v15, s[32:35], s51 offen lds
    s_waitcnt lgkmcnt(0)
    v_mfma_f32_32x32x16_bf16 v[16:31], v[80:83], v[88:91], v[16:31]
    s_waitcnt vmcnt(10)
    ds_read_b64_tr_b16 v[96:97], v160 offset:8192
    ds_read_b64_tr_b16 v[98:99], v160 offset:8704
    ds_read_b128 v[104:107], v11 offset:0
    v_mfma_f32_32x32x16_bf16 v[32:47], v[80:83], v[92:95], v[32:47]
    ds_read_b128 v[108:111], v11 offset:4096
    ds_read_b64_tr_b16 v[100:101], v161 offset:8192
    ds_read_b64_tr_b16 v[102:103], v161 offset:8704
    v_mfma_f32_32x32x16_bf16 v[48:63], v[84:87], v[88:91], v[48:63]
    s_add_u32 m0, s79, 114688
    s_add_u32 s51, s50, 57344
    buffer_load_dwordx4 v14, s[32:35], s51 offen lds
    v_mfma_f32_32x32x16_bf16 v[64:79], v[84:87], v[92:95], v[64:79]
    s_add_u32 m0, s79, 115712
    s_nop 0
    buffer_load_dwordx4 v15, s[32:35], s51 offen lds
    s_waitcnt lgkmcnt(0)
    v_mfma_f32_32x32x16_bf16 v[16:31], v[96:99], v[104:107], v[16:31]
    s_waitcnt vmcnt(10)
    ds_read_b64_tr_b16 v[80:81], v160 offset:16384
    ds_read_b64_tr_b16 v[82:83], v160 offset:16896
    ds_read_b128 v[88:91], v8 offset:8192
    v_mfma_f32_32x32x16_bf16 v[32:47], v[96:99], v[108:111], v[32:47]
    ds_read_b128 v[92:95], v8 offset:12288
    ds_read_b64_tr_b16 v[84:85], v161 offset:16384
    ds_read_b64_tr_b16 v[86:87], v161 offset:16896
    v_mfma_f32_32x32x16_bf16 v[48:63], v[100:103], v[104:107], v[48:63]
    s_add_u32 m0, s79, 122880
    s_add_u32 s51, s50, 114688
    buffer_load_dwordx4 v14, s[32:35], s51 offen lds
    v_mfma_f32_32x32x16_bf16 v[64:79], v[100:103], v[108:111], v[64:79]
    s_add_u32 m0, s79, 123904
    s_nop 0
    buffer_load_dwordx4 v15, s[32:35], s51 offen lds
    s_waitcnt lgkmcnt(0)
    v_mfma_f32_32x32x16_bf16 v[16:31], v[80:83], v[88:91], v[16:31]
    s_waitcnt vmcnt(10)
    ds_read_b64_tr_b16 v[96:97], v162 offset:32768
    ds_read_b64_tr_b16 v[98:99], v162 offset:33280
    ds_read_b128 v[104:107], v9 offset:8192
    v_mfma_f32_32x32x16_bf16 v[32:47], v[80:83], v[92:95], v[32:47]
    ds_read_b128 v[108:111], v9 offset:12288
    ds_read_b64_tr_b16 v[100:101], v163 offset:32768
    ds_read_b64_tr_b16 v[102:103], v163 offset:33280
    v_mfma_f32_32x32x16_bf16 v[48:63], v[84:87], v[88:91], v[48:63]
    s_add_u32 m0, s79, 131072
    s_add_u32 s51, s50, 172032
    buffer_load_dwordx4 v14, s[32:35], s51 offen lds
    v_mfma_f32_32x32x16_bf16 v[64:79], v[84:87], v[92:95], v[64:79]
    s_add_u32 m0, s79, 132096
    s_nop 0
    buffer_load_dwordx4 v15, s[32:35], s51 offen lds
    s_waitcnt lgkmcnt(0)
    v_mfma_f32_32x32x16_bf16 v[16:31], v[96:99], v[104:107], v[16:31]
    s_waitcnt vmcnt(10)
    ds_read_b64_tr_b16 v[80:81], v162 offset:40960
    ds_read_b64_tr_b16 v[82:83], v162 offset:41472
    ds_read_b128 v[88:91], v10 offset:8192
    v_mfma_f32_32x32x16_bf16 v[32:47], v[96:99], v[108:111], v[32:47]
    ds_read_b128 v[92:95], v10 offset:12288
    ds_read_b64_tr_b16 v[84:85], v163 offset:40960
    ds_read_b64_tr_b16 v[86:87], v163 offset:41472
    v_mfma_f32_32x32x16_bf16 v[48:63], v[100:103], v[104:107], v[48:63]
    s_add_u32 s5, s49, 3
    s_and_b32 s5, s5, 7
    s_mul_i32 s50, s5, 229376
    s_add_u32 s50, s50, s76
    s_add_u32 m0, s79, 32768
    s_add_u32 s51, s50, 0
    buffer_load_dwordx4 v14, s[32:35], s51 offen lds
    v_mfma_f32_32x32x16_bf16 v[64:79], v[100:103], v[108:111], v[64:79]
    s_add_u32 m0, s79, 33792
    s_nop 0
    buffer_load_dwordx4 v15, s[32:35], s51 offen lds
    s_waitcnt lgkmcnt(0)
    v_mfma_f32_32x32x16_bf16 v[16:31], v[80:83], v[88:91], v[16:31]
    s_waitcnt vmcnt(10)
    ds_read_b64_tr_b16 v[96:97], v160 offset:24576
    ds_read_b64_tr_b16 v[98:99], v160 offset:25088
    ds_read_b128 v[104:107], v11 offset:8192
    v_mfma_f32_32x32x16_bf16 v[32:47], v[80:83], v[92:95], v[32:47]
    ds_read_b128 v[108:111], v11 offset:12288
    ds_read_b64_tr_b16 v[100:101], v161 offset:24576
    ds_read_b64_tr_b16 v[102:103], v161 offset:25088
    v_mfma_f32_32x32x16_bf16 v[48:63], v[84:87], v[88:91], v[48:63]
    s_add_u32 m0, s79, 40960
    s_add_u32 s51, s50, 57344
    buffer_load_dwordx4 v14, s[32:35], s51 offen lds
    v_mfma_f32_32x32x16_bf16 v[64:79], v[84:87], v[92:95], v[64:79]
    s_add_u32 m0, s79, 41984
    s_nop 0
    buffer_load_dwordx4 v15, s[32:35], s51 offen lds
    s_waitcnt lgkmcnt(0)
    v_mfma_f32_32x32x16_bf16 v[16:31], v[96:99], v[104:107], v[16:31]
    s_waitcnt vmcnt(10)
    ds_read_b64_tr_b16 v[80:81], v160 offset:32768
    ds_read_b64_tr_b16 v[82:83], v160 offset:33280
    ds_read_b128 v[88:91], v8 offset:16384
    v_mfma_f32_32x32x16_bf16 v[32:47], v[96:99], v[108:111], v[32:47]
    ds_read_b128 v[92:95], v8 offset:20480
    ds_read_b64_tr_b16 v[84:85], v161 offset:32768
    ds_read_b64_tr_b16 v[86:87], v161 offset:33280
    v_mfma_f32_32x32x16_bf16 v[48:63], v[100:103], v[104:107], v[48:63]
    s_add_u32 m0, s79, 139264
    s_add_u32 s51, s50, 114688
    buffer_load_dwordx4 v14, s[32:35], s51 offen lds
    v_mfma_f32_32x32x16_bf16 v[64:79], v[100:103], v[108:111], v[64:79]
    s_add_u32 m0, s79, 140288
    s_nop 0
    buffer_load_dwordx4 v15, s[32:35], s51 offen lds
    s_waitcnt lgkmcnt(0)
    v_mfma_f32_32x32x16_bf16 v[16:31], v[80:83], v[88:91], v[16:31]
    s_waitcnt vmcnt(10)
    ds_read_b64_tr_b16 v[96:97], v160 offset:0
    ds_read_b64_tr_b16 v[98:99], v160 offset:512
    ds_read_b128 v[104:107], v9 offset:16384
    v_mfma_f32_32x32x16_bf16 v[32:47], v[80:83], v[92:95], v[32:47]
    ds_read_b128 v[108:111], v9 offset:20480
    ds_read_b64_tr_b16 v[100:101], v161 offset:0
    ds_read_b64_tr_b16 v[102:103], v161 offset:512
    v_mfma_f32_32x32x16_bf16 v[48:63], v[84:87], v[88:91], v[48:63]
    s_add_u32 m0, s79, 147456
    s_add_u32 s51, s50, 172032
    buffer_load_dwordx4 v14, s[32:35], s51 offen lds
    v_mfma_f32_32x32x16_bf16 v[64:79], v[84:87], v[92:95], v[64:79]
    s_add_u32 m0, s79, 148480
    s_nop 0
    buffer_load_dwordx4 v15, s[32:35], s51 offen lds
    s_waitcnt lgkmcnt(0)
    v_mfma_f32_32x32x16_bf16 v[16:31], v[96:99], v[104:107], v[16:31]
    s_waitcnt vmcnt(10)
    ds_read_b64_tr_b16 v[80:81], v160 offset:8192
    ds_read_b64_tr_b16 v[82:83], v160 offset:8704
    ds_read_b128 v[88:91], v10 offset:16384
    v_mfma_f32_32x32x16_bf16 v[32:47], v[96:99], v[108:111], v[32:47]
    ds_read_b128 v[92:95], v10 offset:20480
    ds_read_b64_tr_b16 v[84:85], v161 offset:8192
    ds_read_b64_tr_b16 v[86:87], v161 offset:8704
    v_mfma_f32_32x32x16_bf16 v[48:63], v[100:103], v[104:107], v[48:63]
    s_add_u32 s5, s49, 4
    s_and_b32 s5, s5, 7
    s_mul_i32 s50, s5, 229376
    s_add_u32 s50, s50, s76
    s_add_u32 m0, s79, 114688
    s_add_u32 s51, s50, 0
    buffer_load_dwordx4 v14, s[32:35], s51 offen lds
    v_mfma_f32_32x32x16_bf16 v[64:79], v[100:103], v[108:111], v[64:79]
    s_add_u32 m0, s79, 115712
    s_nop 0
    buffer_load_dwordx4 v15, s[32:35], s51 offen lds
    s_waitcnt lgkmcnt(0)
    v_mfma_f32_32x32x16_bf16 v[16:31], v[80:83], v[88:91], v[16:31]
    s_waitcnt vmcnt(10)
    ds_read_b64_tr_b16 v[96:97], v160 offset:16384
    ds_read_b64_tr_b16 v[98:99], v160 offset:16896
    ds_read_b128 v[104:107], v11 offset:16384
    v_mfma_f32_32x32x16_bf16 v[32:47], v[80:83], v[92:95], v[32:47]
    ds_read_b128 v[108:111], v11 offset:20480
    ds_read_b64_tr_b16 v[100:101], v161 offset:16384
    ds_read_b64_tr_b16 v[102:103], v161 offset:16896
    v_mfma_f32_32x32x16_bf16 v[48:63], v[84:87], v[88:91], v[48:63]
    s_add_u32 m0, s79, 122880
    s_add_u32 s51, s50, 57344
    buffer_load_dwordx4 v14, s[32:35], s51 offen lds
    v_mfma_f32_32x32x16_bf16 v[64:79], v[84:87], v[92:95], v[64:79]
    s_add_u32 m0, s79, 123904
    s_nop 0
    buffer_load_dwordx4 v15, s[32:35], s51 offen lds
    s_waitcnt lgkmcnt(0)
    v_mfma_f32_32x32x16_bf16 v[16:31], v[96:99], v[104:107], v[16:31]
    s_waitcnt vmcnt(10)
    ds_read_b64_tr_b16 v[80:81], v162 offset:32768
    ds_read_b64_tr_b16 v[82:83], v162 offset:33280
    ds_read_b128 v[88:91], v8 offset:24576
    v_mfma_f32_32x32x16_bf16 v[32:47], v[96:99], v[108:111], v[32:47]
    ds_read_b128 v[92:95], v8 offset:28672
    ds_read_b64_tr_b16 v[84:85], v163 offset:32768
    ds_read_b64_tr_b16 v[86:87], v163 offset:33280
    v_mfma_f32_32x32x16_bf16 v[48:63], v[100:103], v[104:107], v[48:63]
    s_add_u32 m0, s79, 131072
    s_add_u32 s51, s50, 114688
    buffer_load_dwordx4 v14, s[32:35], s51 offen lds
    v_mfma_f32_32x32x16_bf16 v[64:79], v[100:103], v[108:111], v[64:79]
    s_add_u32 m0, s79, 132096
    s_nop 0
    buffer_load_dwordx4 v15, s[32:35], s51 offen lds
    s_waitcnt lgkmcnt(0)
    v_mfma_f32_32x32x16_bf16 v[16:31], v[80:83], v[88:91], v[16:31]
    s_waitcnt vmcnt(10)
    ds_read_b64_tr_b16 v[96:97], v162 offset:40960
    ds_read_b64_tr_b16 v[98:99], v162 offset:41472
    ds_read_b128 v[104:107], v9 offset:24576
    v_mfma_f32_32x32x16_bf16 v[32:47], v[80:83], v[92:95], v[32:47]
    ds_read_b128 v[108:111], v9 offset:28672
    ds_read_b64_tr_b16 v[100:101], v163 offset:40960
    ds_read_b64_tr_b16 v[102:103], v163 offset:41472
    v_mfma_f32_32x32x16_bf16 v[48:63], v[84:87], v[88:91], v[48:63]
    s_add_u32 m0, s79, 32768
    s_add_u32 s51, s50, 172032
    buffer_load_dwordx4 v14, s[32:35], s51 offen lds
    v_mfma_f32_32x32x16_bf16 v[64:79], v[84:87], v[92:95], v[64:79]
    s_add_u32 m0, s79, 33792
    s_nop 0
    buffer_load_dwordx4 v15, s[32:35], s51 offen lds
    s_waitcnt lgkmcnt(0)
    v_mfma_f32_32x32x16_bf16 v[16:31], v[96:99], v[104:107], v[16:31]
    s_waitcnt vmcnt(10)
    ds_read_b64_tr_b16 v[80:81], v160 offset:24576
    ds_read_b64_tr_b16 v[82:83], v160 offset:25088
    ds_read_b128 v[88:91], v10 offset:24576
    v_mfma_f32_32x32x16_bf16 v[32:47], v[96:99], v[108:111], v[32:47]
    ds_read_b128 v[92:95], v10 offset:28672
    ds_read_b64_tr_b16 v[84:85], v161 offset:24576
    ds_read_b64_tr_b16 v[86:87], v161 offset:25088
    v_mfma_f32_32x32x16_bf16 v[48:63], v[100:103], v[104:107], v[48:63]
    s_add_u32 s5, s49, 5
    s_and_b32 s5, s5, 7
    s_mul_i32 s50, s5, 229376
    s_add_u32 s50, s50, s76
    s_add_u32 m0, s79, 40960
    s_add_u32 s51, s50, 0
    buffer_load_dwordx4 v14, s[32:35], s51 offen lds
    v_mfma_f32_32x32x16_bf16 v[64:79], v[100:103], v[108:111], v[64:79]
    s_add_u32 m0, s79, 41984
    s_nop 0
    buffer_load_dwordx4 v15, s[32:35], s51 offen lds
    s_waitcnt lgkmcnt(0)
    v_mfma_f32_32x32x16_bf16 v[16:31], v[80:83], v[88:91], v[16:31]
    s_waitcnt vmcnt(10)
    ds_read_b64_tr_b16 v[96:97], v160 offset:32768
    ds_read_b64_tr_b16 v[98:99], v160 offset:33280
    ds_read_b128 v[104:107], v11 offset:24576
    v_mfma_f32_32x32x16_bf16 v[32:47], v[80:83], v[92:95], v[32:47]
    ds_read_b128 v[108:111], v11 offset:28672
    ds_read_b64_tr_b16 v[100:101], v161 offset:32768
    ds_read_b64_tr_b16 v[102:103], v161 offset:33280
    v_mfma_f32_32x32x16_bf16 v[48:63], v[84:87], v[88:91], v[48:63]
    s_add_u32 m0, s79, 139264
    s_add_u32 s51, s50, 57344
    buffer_load_dwordx4 v14, s[32:35], s51 offen lds
    v_mfma_f32_32x32x16_bf16 v[64:79], v[84:87], v[92:95], v[64:79]
    s_add_u32 m0, s79, 140288
    s_nop 0
    buffer_load_dwordx4 v15, s[32:35], s51 offen lds
    s_waitcnt lgkmcnt(0)
    v_mfma_f32_32x32x16_bf16 v[16:31], v[96:99], v[104:107], v[16:31]
    s_waitcnt vmcnt(10)
    ds_read_b64_tr_b16 v[80:81], v160 offset:0
    ds_read_b64_tr_b16 v[82:83], v160 offset:512
    ds_read_b128 v[88:91], v8 offset:32768
    v_mfma_f32_32x32x16_bf16 v[32:47], v[96:99], v[108:111], v[32:47]
    ds_read_b128 v[92:95], v8 offset:36864
    ds_read_b64_tr_b16 v[84:85], v161 offset:0
    ds_read_b64_tr_b16 v[86:87], v161 offset:512
    v_mfma_f32_32x32x16_bf16 v[48:63], v[100:103], v[104:107], v[48:63]
    s_add_u32 m0, s79, 147456
    s_add_u32 s51, s50, 114688
    buffer_load_dwordx4 v14, s[32:35], s51 offen lds
    v_mfma_f32_32x32x16_bf16 v[64:79], v[100:103], v[108:111], v[64:79]
    s_add_u32 m0, s79, 148480
    s_nop 0
    buffer_load_dwordx4 v15, s[32:35], s51 offen lds
    s_waitcnt lgkmcnt(0)
    v_mfma_f32_32x32x16_bf16 v[16:31], v[80:83], v[88:91], v[16:31]
    s_waitcnt vmcnt(10)
    ds_read_b64_tr_b16 v[96:97], v160 offset:8192
    ds_read_b64_tr_b16 v[98:99], v160 offset:8704
    ds_read_b128 v[104:107], v9 offset:32768
    v_mfma_f32_32x32x16_bf16 v[32:47], v[80:83], v[92:95], v[32:47]
    ds_read_b128 v[108:111], v9 offset:36864
    ds_read_b64_tr_b16 v[100:101], v161 offset:8192
    ds_read_b64_tr_b16 v[102:103], v161 offset:8704
    v_mfma_f32_32x32x16_bf16 v[48:63], v[84:87], v[88:91], v[48:63]
    s_add_u32 m0, s79, 114688
    s_add_u32 s51, s50, 172032
    buffer_load_dwordx4 v14, s[32:35], s51 offen lds
    v_mfma_f32_32x32x16_bf16 v[64:79], v[84:87], v[92:95], v[64:79]
    s_add_u32 m0, s79, 115712
    s_nop 0
    buffer_load_dwordx4 v15, s[32:35], s51 offen lds
    s_waitcnt lgkmcnt(0)
    v_mfma_f32_32x32x16_bf16 v[16:31], v[96:99], v[104:107], v[16:31]
    s_waitcnt vmcnt(10)
    ds_read_b64_tr_b16 v[80:81], v160 offset:16384
    ds_read_b64_tr_b16 v[82:83], v160 offset:16896
    ds_read_b128 v[88:91], v10 offset:32768
    v_mfma_f32_32x32x16_bf16 v[32:47], v[96:99], v[108:111], v[32:47]
    ds_read_b128 v[92:95], v10 offset:36864
    ds_read_b64_tr_b16 v[84:85], v161 offset:16384
    ds_read_b64_tr_b16 v[86:87], v161 offset:16896
    v_mfma_f32_32x32x16_bf16 v[48:63], v[100:103], v[104:107], v[48:63]
    s_add_u32 s5, s49, 6
    s_and_b32 s5, s5, 7
    s_mul_i32 s50, s5, 229376
    s_add_u32 s50, s50, s76
    s_add_u32 m0, s79, 122880
    s_add_u32 s51, s50, 0
    buffer_load_dwordx4 v14, s[32:35], s51 offen lds
    v_mfma_f32_32x32x16_bf16 v[64:79], v[100:103], v[108:111], v[64:79]
    s_add_u32 m0, s79, 123904
    s_nop 0
    buffer_load_dwordx4 v15, s[32:35], s51 offen lds
    s_waitcnt lgkmcnt(0)
    v_mfma_f32_32x32x16_bf16 v[16:31], v[80:83], v[88:91], v[16:31]
    s_waitcnt vmcnt(10)
    ds_read_b64_tr_b16 v[96:97], v162 offset:32768
    ds_read_b64_tr_b16 v[98:99], v162 offset:33280
    ds_read_b128 v[104:107], v11 offset:32768
    v_mfma_f32_32x32x16_bf16 v[32:47], v[80:83], v[92:95], v[32:47]
    ds_read_b128 v[108:111], v11 offset:36864
    ds_read_b64_tr_b16 v[100:101], v163 offset:32768
    ds_read_b64_tr_b16 v[102:103], v163 offset:33280
    v_mfma_f32_32x32x16_bf16 v[48:63], v[84:87], v[88:91], v[48:63]
    s_add_u32 m0, s79, 131072
    s_add_u32 s51, s50, 57344
    buffer_load_dwordx4 v14, s[32:35], s51 offen lds
    v_mfma_f32_32x32x16_bf16 v[64:79], v[84:87], v[92:95], v[64:79]
    s_add_u32 m0, s79, 132096
    s_nop 0
    buffer_load_dwordx4 v15, s[32:35], s51 offen lds
    s_waitcnt lgkmcnt(0)
    v_mfma_f32_32x32x16_bf16 v[16:31], v[96:99], v[104:107], v[16:31]
    s_waitcnt vmcnt(10)
    ds_read_b64_tr_b16 v[80:81], v162 offset:40960
    ds_read_b64_tr_b16 v[82:83], v162 offset:41472
    ds_read_b128 v[88:91], v8 offset:40960
    v_mfma_f32_32x32x16_bf16 v[32:47], v[96:99], v[108:111], v[32:47]
    ds_read_b128 v[92:95], v8 offset:45056
    ds_read_b64_tr_b16 v[84:85], v163 offset:40960
    ds_read_b64_tr_b16 v[86:87], v163 offset:41472
    v_mfma_f32_32x32x16_bf16 v[48:63], v[100:103], v[104:107], v[48:63]
    s_add_u32 m0, s79, 32768
    s_add_u32 s51, s50, 114688
    buffer_load_dwordx4 v14, s[32:35], s51 offen lds
    v_mfma_f32_32x32x16_bf16 v[64:79], v[100:103], v[108:111], v[64:79]
    s_add_u32 m0, s79, 33792
    s_nop 0
    buffer_load_dwordx4 v15, s[32:35], s51 offen lds
    s_waitcnt lgkmcnt(0)
    v_mfma_f32_32x32x16_bf16 v[16:31], v[80:83], v[88:91], v[16:31]
    s_waitcnt vmcnt(10)
    ds_read_b64_tr_b16 v[96:97], v160 offset:24576
    ds_read_b64_tr_b16 v[98:99], v160 offset:25088
    ds_read_b128 v[104:107], v9 offset:40960
    v_mfma_f32_32x32x16_bf16 v[32:47], v[80:83], v[92:95], v[32:47]
    ds_read_b128 v[108:111], v9 offset:45056
    ds_read_b64_tr_b16 v[100:101], v161 offset:24576
    ds_read_b64_tr_b16 v[102:103], v161 offset:25088
    v_mfma_f32_32x32x16_bf16 v[48:63], v[84:87], v[88:91], v[48:63]
    s_add_u32 m0, s79, 40960
    s_add_u32 s51, s50, 172032
    buffer_load_dwordx4 v14, s[32:35], s51 offen lds
    v_mfma_f32_32x32x16_bf16 v[64:79], v[84:87], v[92:95], v[64:79]
    s_add_u32 m0, s79, 41984
    s_nop 0
    buffer_load_dwordx4 v15, s[32:35], s51 offen lds
    s_waitcnt lgkmcnt(0)
    v_mfma_f32_32x32x16_bf16 v[16:31], v[96:99], v[104:107], v[16:31]
    s_waitcnt vmcnt(10)
    ds_read_b64_tr_b16 v[80:81], v160 offset:32768
    ds_read_b64_tr_b16 v[82:83], v160 offset:33280
    ds_read_b128 v[88:91], v10 offset:40960
    v_mfma_f32_32x32x16_bf16 v[32:47], v[96:99], v[108:111], v[32:47]
    ds_read_b128 v[92:95], v10 offset:45056
    ds_read_b64_tr_b16 v[84:85], v161 offset:32768
    ds_read_b64_tr_b16 v[86:87], v161 offset:33280
    v_mfma_f32_32x32x16_bf16 v[48:63], v[100:103], v[104:107], v[48:63]
    s_add_u32 s5, s49, 7
    s_and_b32 s5, s5, 7
    s_mul_i32 s50, s5, 229376
    s_add_u32 s50, s50, s76
    s_add_u32 m0, s79, 139264
    s_add_u32 s51, s50, 0
    buffer_load_dwordx4 v14, s[32:35], s51 offen lds
    v_mfma_f32_32x32x16_bf16 v[64:79], v[100:103], v[108:111], v[64:79]
    s_add_u32 m0, s79, 140288
    s_nop 0
    buffer_load_dwordx4 v15, s[32:35], s51 offen lds
    s_waitcnt lgkmcnt(0)
    v_mfma_f32_32x32x16_bf16 v[16:31], v[80:83], v[88:91], v[16:31]
    s_waitcnt vmcnt(10)
    ds_read_b64_tr_b16 v[96:97], v160 offset:0
    ds_read_b64_tr_b16 v[98:99], v160 offset:512
    ds_read_b128 v[104:107], v11 offset:40960
    v_mfma_f32_32x32x16_bf16 v[32:47], v[80:83], v[92:95], v[32:47]
    ds_read_b128 v[108:111], v11 offset:45056
    ds_read_b64_tr_b16 v[100:101], v161 offset:0
    ds_read_b64_tr_b16 v[102:103], v161 offset:512
    v_mfma_f32_32x32x16_bf16 v[48:63], v[84:87], v[88:91], v[48:63]
    s_add_u32 m0, s79, 147456
    s_add_u32 s51, s50, 57344
    buffer_load_dwordx4 v14, s[32:35], s51 offen lds
    v_mfma_f32_32x32x16_bf16 v[64:79], v[84:87], v[92:95], v[64:79]
    s_add_u32 m0, s79, 148480
    s_nop 0
    buffer_load_dwordx4 v15, s[32:35], s51 offen lds
    s_waitcnt lgkmcnt(0)
    v_mfma_f32_32x32x16_bf16 v[16:31], v[96:99], v[104:107], v[16:31]
    s_waitcnt vmcnt(10)
    ds_read_b64_tr_b16 v[80:81], v160 offset:8192
    ds_read_b64_tr_b16 v[82:83], v160 offset:8704
    ds_read_b128 v[88:91], v8 offset:49152
    v_mfma_f32_32x32x16_bf16 v[32:47], v[96:99], v[108:111], v[32:47]
    ds_read_b128 v[92:95], v8 offset:53248
    ds_read_b64_tr_b16 v[84:85], v161 offset:8192
    ds_read_b64_tr_b16 v[86:87], v161 offset:8704
    v_mfma_f32_32x32x16_bf16 v[48:63], v[100:103], v[104:107], v[48:63]
    s_add_u32 m0, s79, 114688
    s_add_u32 s51, s50, 114688
    buffer_load_dwordx4 v14, s[32:35], s51 offen lds
    v_mfma_f32_32x32x16_bf16 v[64:79], v[100:103], v[108:111], v[64:79]
    s_add_u32 m0, s79, 115712
    s_nop 0
    buffer_load_dwordx4 v15, s[32:35], s51 offen lds
    s_waitcnt lgkmcnt(0)
    v_mfma_f32_32x32x16_bf16 v[16:31], v[80:83], v[88:91], v[16:31]
    s_waitcnt vmcnt(10)
    ds_read_b64_tr_b16 v[96:97], v160 offset:16384
    ds_read_b64_tr_b16 v[98:99], v160 offset:16896
    ds_read_b128 v[104:107], v9 offset:49152
    v_mfma_f32_32x32x16_bf16 v[32:47], v[80:83], v[92:95], v[32:47]
    ds_read_b128 v[108:111], v9 offset:53248
    ds_read_b64_tr_b16 v[100:101], v161 offset:16384
    ds_read_b64_tr_b16 v[102:103], v161 offset:16896
    v_mfma_f32_32x32x16_bf16 v[48:63], v[84:87], v[88:91], v[48:63]
    s_add_u32 m0, s79, 122880
    s_add_u32 s51, s50, 172032
    buffer_load_dwordx4 v14, s[32:35], s51 offen lds
    v_mfma_f32_32x32x16_bf16 v[64:79], v[84:87], v[92:95], v[64:79]
    s_add_u32 m0, s79, 123904
    s_nop 0
    buffer_load_dwordx4 v15, s[32:35], s51 offen lds
    s_waitcnt lgkmcnt(0)
    v_mfma_f32_32x32x16_bf16 v[16:31], v[96:99], v[104:107], v[16:31]
    s_waitcnt vmcnt(10)
    ds_read_b64_tr_b16 v[80:81], v162 offset:32768
    ds_read_b64_tr_b16 v[82:83], v162 offset:33280
    ds_read_b128 v[88:91], v10 offset:49152
    v_mfma_f32_32x32x16_bf16 v[32:47], v[96:99], v[108:111], v[32:47]
    ds_read_b128 v[92:95], v10 offset:53248
    ds_read_b64_tr_b16 v[84:85], v163 offset:32768
    ds_read_b64_tr_b16 v[86:87], v163 offset:33280
    v_mfma_f32_32x32x16_bf16 v[48:63], v[100:103], v[104:107], v[48:63]
    v_mfma_f32_32x32x16_bf16 v[64:79], v[100:103], v[108:111], v[64:79]
    s_waitcnt lgkmcnt(0)
    v_mfma_f32_32x32x16_bf16 v[16:31], v[80:83], v[88:91], v[16:31]
    s_waitcnt vmcnt(8)
    ds_read_b64_tr_b16 v[96:97], v162 offset:40960
    ds_read_b64_tr_b16 v[98:99], v162 offset:41472
    ds_read_b128 v[104:107], v11 offset:49152
    v_mfma_f32_32x32x16_bf16 v[32:47], v[80:83], v[92:95], v[32:47]
    ds_read_b128 v[108:111], v11 offset:53248
    ds_read_b64_tr_b16 v[100:101], v163 offset:40960
    ds_read_b64_tr_b16 v[102:103], v163 offset:41472
    v_mfma_f32_32x32x16_bf16 v[48:63], v[84:87], v[88:91], v[48:63]
    v_mfma_f32_32x32x16_bf16 v[64:79], v[84:87], v[92:95], v[64:79]
    s_waitcnt lgkmcnt(0)
    v_mfma_f32_32x32x16_bf16 v[16:31], v[96:99], v[104:107], v[16:31]
    s_waitcnt vmcnt(6)
    ds_read_b64_tr_b16 v[80:81], v160 offset:24576
    ds_read_b64_tr_b16 v[82:83], v160 offset:25088
    ds_read_b128 v[88:91], v8 offset:57344
    v_mfma_f32_32x32x16_bf16 v[32:47], v[96:99], v[108:111], v[32:47]
    ds_read_b128 v[92:95], v8 offset:61440
    ds_read_b64_tr_b16 v[84:85], v161 offset:24576
    ds_read_b64_tr_b16 v[86:87], v161 offset:25088
    v_mfma_f32_32x32x16_bf16 v[48:63], v[100:103], v[104:107], v[48:63]
    v_mfma_f32_32x32x16_bf16 v[64:79], v[100:103], v[108:111], v[64:79]
    buffer_load_dword v164, v165, s[36:39], s77 offen sc1
    s_waitcnt lgkmcnt(0)
    v_mfma_f32_32x32x16_bf16 v[16:31], v[80:83], v[88:91], v[16:31]
    s_waitcnt vmcnt(5)
    ds_read_b64_tr_b16 v[96:97], v160 offset:32768
    ds_read_b64_tr_b16 v[98:99], v160 offset:33280
    ds_read_b128 v[104:107], v9 offset:57344
    v_mfma_f32_32x32x16_bf16 v[32:47], v[80:83], v[92:95], v[32:47]
    ds_read_b128 v[108:111], v9 offset:61440
    ds_read_b64_tr_b16 v[100:101], v161 offset:32768
    ds_read_b64_tr_b16 v[102:103], v161 offset:33280
    v_mfma_f32_32x32x16_bf16 v[48:63], v[84:87], v[88:91], v[48:63]
    v_mfma_f32_32x32x16_bf16 v[64:79], v[84:87], v[92:95], v[64:79]
    s_waitcnt lgkmcnt(0)
    v_mfma_f32_32x32x16_bf16 v[16:31], v[96:99], v[104:107], v[16:31]
    s_waitcnt vmcnt(3)
    ds_read_b64_tr_b16 v[80:81], v160 offset:0
    ds_read_b64_tr_b16 v[82:83], v160 offset:512
    ds_read_b128 v[88:91], v10 offset:57344
    v_mfma_f32_32x32x16_bf16 v[32:47], v[96:99], v[108:111], v[32:47]
    ds_read_b128 v[92:95], v10 offset:61440
    ds_read_b64_tr_b16 v[84:85], v161 offset:0
    ds_read_b64_tr_b16 v[86:87], v161 offset:512
    v_mfma_f32_32x32x16_bf16 v[48:63], v[100:103], v[104:107], v[48:63]
    v_mfma_f32_32x32x16_bf16 v[64:79], v[100:103], v[108:111], v[64:79]
    s_waitcnt lgkmcnt(0)
    v_mfma_f32_32x32x16_bf16 v[16:31], v[80:83], v[88:91], v[16:31]
    s_waitcnt vmcnt(1)
    ds_read_b64_tr_b16 v[96:97], v160 offset:8192
    ds_read_b64_tr_b16 v[98:99], v160 offset:8704
    ds_read_b128 v[104:107], v11 offset:57344
    v_mfma_f32_32x32x16_bf16 v[32:47], v[80:83], v[92:95], v[32:47]
    ds_read_b128 v[108:111], v11 offset:61440
    ds_read_b64_tr_b16 v[100:101], v161 offset:8192
    ds_read_b64_tr_b16 v[102:103], v161 offset:8704
    v_mfma_f32_32x32x16_bf16 v[48:63], v[84:87], v[88:91], v[48:63]
    v_mfma_f32_32x32x16_bf16 v[64:79], v[84:87], v[92:95], v[64:79]
    s_waitcnt lgkmcnt(0)
    v_mfma_f32_32x32x16_bf16 v[16:31], v[96:99], v[104:107], v[16:31]
    v_mfma_f32_32x32x16_bf16 v[32:47], v[96:99], v[108:111], v[32:47]
    v_mfma_f32_32x32x16_bf16 v[48:63], v[100:103], v[104:107], v[48:63]
    v_mfma_f32_32x32x16_bf16 v[64:79], v[100:103], v[108:111], v[64:79]
    s_branch L_f1done
L_f1g:
    v_lshrrev_b32 v4, 5, v1
    v_lshlrev_b32 v4, 4, v4
    s_add_u32 s5, s79, 139264
    v_add_u32 v4, s5, v4
    s_waitcnt vmcnt(0)
    ds_read_b128 v[80:83], v4 offset:0
    ds_read_b128 v[84:87], v8 offset:0
    ds_read_b128 v[88:91], v8 offset:4096
    ds_read_b128 v[92:95], v4 offset:32
    ds_read_b128 v[96:99], v9 offset:0
    ds_read_b128 v[100:103], v9 offset:4096
    ds_read_b128 v[104:107], v4 offset:64
    ds_read_b128 v[108:111], v10 offset:0
    ds_read_b128 v[112:115], v10 offset:4096
    ds_read_b128 v[116:119], v4 offset:96
    ds_read_b128 v[120:123], v11 offset:0
    ds_read_b128 v[124:127], v11 offset:4096
    s_waitcnt lgkmcnt(0)
    v_mfma_f32_32x32x16_bf16 v[16:31], v[80:83], v[84:87], 0
    v_mfma_f32_32x32x16_bf16 v[32:47], v[80:83], v[88:91], 0
    v_mfma_f32_32x32x16_bf16 v[16:31], v[92:95], v[96:99], v[16:31]
    v_mfma_f32_32x32x16_bf16 v[32:47], v[92:95], v[100:103], v[32:47]
    v_mfma_f32_32x32x16_bf16 v[16:31], v[104:107], v[108:111], v[16:31]
    v_mfma_f32_32x32x16_bf16 v[32:47], v[104:107], v[112:115], v[32:47]
    v_mfma_f32_32x32x16_bf16 v[16:31], v[116:119], v[120:123], v[16:31]
    v_mfma_f32_32x32x16_bf16 v[32:47], v[116:119], v[124:127], v[32:47]
    ds_read_b128 v[80:83], v4 offset:128
    ds_read_b128 v[84:87], v8 offset:8192
    ds_read_b128 v[88:91], v8 offset:12288
    ds_read_b128 v[92:95], v4 offset:160
    ds_read_b128 v[96:99], v9 offset:8192
    ds_read_b128 v[100:103], v9 offset:12288
    ds_read_b128 v[104:107], v4 offset:192
    ds_read_b128 v[108:111], v10 offset:8192
    ds_read_b128 v[112:115], v10 offset:12288
    ds_read_b128 v[116:119], v4 offset:224
    ds_read_b128 v[120:123], v11 offset:8192
    ds_read_b128 v[124:127], v11 offset:12288
    s_waitcnt lgkmcnt(0)
    v_mfma_f32_32x32x16_bf16 v[16:31], v[80:83], v[84:87], v[16:31]
    v_mfma_f32_32x32x16_bf16 v[32:47], v[80:83], v[88:91], v[32:47]
    v_mfma_f32_32x32x16_bf16 v[16:31], v[92:95], v[96:99], v[16:31]
    v_mfma_f32_32x32x16_bf16 v[32:47], v[92:95], v[100:103], v[32:47]
    v_mfma_f32_32x32x16_bf16 v[16:31], v[104:107], v[108:111], v[16:31]
    v_mfma_f32_32x32x16_bf16 v[32:47], v[104:107], v[112:115], v[32:47]
    v_mfma_f32_32x32x16_bf16 v[16:31], v[116:119], v[120:123], v[16:31]
    v_mfma_f32_32x32x16_bf16 v[32:47], v[116:119], v[124:127], v[32:47]
    ds_read_b128 v[80:83], v4 offset:256
    ds_read_b128 v[84:87], v8 offset:16384
    ds_read_b128 v[88:91], v8 offset:20480
    ds_read_b128 v[92:95], v4 offset:288
    ds_read_b128 v[96:99], v9 offset:16384
    ds_read_b128 v[100:103], v9 offset:20480
    ds_read_b128 v[104:107], v4 offset:320
    ds_read_b128 v[108:111], v10 offset:16384
    ds_read_b128 v[112:115], v10 offset:20480
    ds_read_b128 v[116:119], v4 offset:352
    ds_read_b128 v[120:123], v11 offset:16384
    ds_read_b128 v[124:127], v11 offset:20480
    s_waitcnt lgkmcnt(0)
    v_mfma_f32_32x32x16_bf16 v[16:31], v[80:83], v[84:87], v[16:31]
    v_mfma_f32_32x32x16_bf16 v[32:47], v[80:83], v[88:91], v[32:47]
    v_mfma_f32_32x32x16_bf16 v[16:31], v[92:95], v[96:99], v[16:31]
    v_mfma_f32_32x32x16_bf16 v[32:47], v[92:95], v[100:103], v[32:47]
    v_mfma_f32_32x32x16_bf16 v[16:31], v[104:107], v[108:111], v[16:31]
    v_mfma_f32_32x32x16_bf16 v[32:47], v[104:107], v[112:115], v[32:47]
    v_mfma_f32_32x32x16_bf16 v[16:31], v[116:119], v[120:123], v[16:31]
    v_mfma_f32_32x32x16_bf16 v[32:47], v[116:119], v[124:127], v[32:47]
    ds_read_b128 v[80:83], v4 offset:384
    ds_read_b128 v[84:87], v8 offset:24576
    ds_read_b128 v[88:91], v8 offset:28672
    ds_read_b128 v[92:95], v4 offset:416
    ds_read_b128 v[96:99], v9 offset:24576
    ds_read_b128 v[100:103], v9 offset:28672
    ds_read_b128 v[104:107], v4 offset:448
    ds_read_b128 v[108:111], v10 offset:24576
    ds_read_b128 v[112:115], v10 offset:28672
    ds_read_b128 v[116:119], v4 offset:480
    ds_read_b128 v[120:123], v11 offset:24576
    ds_read_b128 v[124:127], v11 offset:28672
    s_waitcnt lgkmcnt(0)
    v_mfma_f32_32x32x16_bf16 v[16:31], v[80:83], v[84:87], v[16:31]
    v_mfma_f32_32x32x16_bf16 v[32:47], v[80:83], v[88:91], v[32:47]
    v_mfma_f32_32x32x16_bf16 v[16:31], v[92:95], v[96:99], v[16:31]
    v_mfma_f32_32x32x16_bf16 v[32:47], v[92:95], v[100:103], v[32:47]
    v_mfma_f32_32x32x16_bf16 v[16:31], v[104:107], v[108:111], v[16:31]
    v_mfma_f32_32x32x16_bf16 v[32:47], v[104:107], v[112:115], v[32:47]
    v_mfma_f32_32x32x16_bf16 v[16:31], v[116:119], v[120:123], v[16:31]
    v_mfma_f32_32x32x16_bf16 v[32:47], v[116:119], v[124:127], v[32:47]
    ds_read_b128 v[80:83], v4 offset:512
    ds_read_b128 v[84:87], v8 offset:32768
    ds_read_b128 v[88:91], v8 offset:36864
    ds_read_b128 v[92:95], v4 offset:544
    ds_read_b128 v[96:99], v9 offset:32768
    ds_read_b128 v[100:103], v9 offset:36864
    ds_read_b128 v[104:107], v4 offset:576
    ds_read_b128 v[108:111], v10 offset:32768
    ds_read_b128 v[112:115], v10 offset:36864
    ds_read_b128 v[116:119], v4 offset:608
    ds_read_b128 v[120:123], v11 offset:32768
    ds_read_b128 v[124:127], v11 offset:36864
    s_waitcnt lgkmcnt(0)
    v_mfma_f32_32x32x16_bf16 v[16:31], v[80:83], v[84:87], v[16:31]
    v_mfma_f32_32x32x16_bf16 v[32:47], v[80:83], v[88:91], v[32:47]
    v_mfma_f32_32x32x16_bf16 v[16:31], v[92:95], v[96:99], v[16:31]
    v_mfma_f32_32x32x16_bf16 v[32:47], v[92:95], v[100:103], v[32:47]
    v_mfma_f32_32x32x16_bf16 v[16:31], v[104:107], v[108:111], v[16:31]
    v_mfma_f32_32x32x16_bf16 v[32:47], v[104:107], v[112:115], v[32:47]
    v_mfma_f32_32x32x16_bf16 v[16:31], v[116:119], v[120:123], v[16:31]
    v_mfma_f32_32x32x16_bf16 v[32:47], v[116:119], v[124:127], v[32:47]
    ds_read_b128 v[80:83], v4 offset:640
    ds_read_b128 v[84:87], v8 offset:40960
    ds_read_b128 v[88:91], v8 offset:45056
    ds_read_b128 v[92:95], v4 offset:672
    ds_read_b128 v[96:99], v9 offset:40960
    ds_read_b128 v[100:103], v9 offset:45056
    ds_read_b128 v[104:107], v4 offset:704
    ds_read_b128 v[108:111], v10 offset:40960
    ds_read_b128 v[112:115], v10 offset:45056
    ds_read_b128 v[116:119], v4 offset:736
    ds_read_b128 v[120:123], v11 offset:40960
    ds_read_b128 v[124:127], v11 offset:45056
    s_waitcnt lgkmcnt(0)
    v_mfma_f32_32x32x16_bf16 v[16:31], v[80:83], v[84:87], v[16:31]
    v_mfma_f32_32x32x16_bf16 v[32:47], v[80:83], v[88:91], v[32:47]
    v_mfma_f32_32x32x16_bf16 v[16:31], v[92:95], v[96:99], v[16:31]
    v_mfma_f32_32x32x16_bf16 v[32:47], v[92:95], v[100:103], v[32:47]
    v_mfma_f32_32x32x16_bf16 v[16:31], v[104:107], v[108:111], v[16:31]
    v_mfma_f32_32x32x16_bf16 v[32:47], v[104:107], v[112:115], v[32:47]
    v_mfma_f32_32x32x16_bf16 v[16:31], v[116:119], v[120:123], v[16:31]
    v_mfma_f32_32x32x16_bf16 v[32:47], v[116:119], v[124:127], v[32:47]
    ds_read_b128 v[80:83], v4 offset:768
    ds_read_b128 v[84:87], v8 offset:49152
    ds_read_b128 v[88:91], v8 offset:53248
    ds_read_b128 v[92:95], v4 offset:800
    ds_read_b128 v[96:99], v9 offset:49152
    ds_read_b128 v[100:103], v9 offset:53248
    ds_read_b128 v[104:107], v4 offset:832
    ds_read_b128 v[108:111], v10 offset:49152
    ds_read_b128 v[112:115], v10 offset:53248
    ds_read_b128 v[116:119], v4 offset:864
    ds_read_b128 v[120:123], v11 offset:49152
    ds_read_b128 v[124:127], v11 offset:53248
    s_waitcnt lgkmcnt(0)
    v_mfma_f32_32x32x16_bf16 v[16:31], v[80:83], v[84:87], v[16:31]
    v_mfma_f32_32x32x16_bf16 v[32:47], v[80:83], v[88:91], v[32:47]
    v_mfma_f32_32x32x16_bf16 v[16:31], v[92:95], v[96:99], v[16:31]
    v_mfma_f32_32x32x16_bf16 v[32:47], v[92:95], v[100:103], v[32:47]
    v_mfma_f32_32x32x16_bf16 v[16:31], v[104:107], v[108:111], v[16:31]
    v_mfma_f32_32x32x16_bf16 v[32:47], v[104:107], v[112:115], v[32:47]
    v_mfma_f32_32x32x16_bf16 v[16:31], v[116:119], v[120:123], v[16:31]
    v_mfma_f32_32x32x16_bf16 v[32:47], v[116:119], v[124:127], v[32:47]
    ds_read_b128 v[80:83], v4 offset:896
    ds_read_b128 v[84:87], v8 offset:57344
    ds_read_b128 v[88:91], v8 offset:61440
    ds_read_b128 v[92:95], v4 offset:928
    ds_read_b128 v[96:99], v9 offset:57344
    ds_read_b128 v[100:103], v9 offset:61440
    ds_read_b128 v[104:107], v4 offset:960
    ds_read_b128 v[108:111], v10 offset:57344
    ds_read_b128 v[112:115], v10 offset:61440
    ds_read_b128 v[116:119], v4 offset:992
    ds_read_b128 v[120:123], v11 offset:57344
    ds_read_b128 v[124:127], v11 offset:61440
    s_waitcnt lgkmcnt(0)
    v_mfma_f32_32x32x16_bf16 v[16:31], v[80:83], v[84:87], v[16:31]
    v_mfma_f32_32x32x16_bf16 v[32:47], v[80:83], v[88:91], v[32:47]
    v_mfma_f32_32x32x16_bf16 v[16:31], v[92:95], v[96:99], v[16:31]
    v_mfma_f32_32x32x16_bf16 v[32:47], v[92:95], v[100:103], v[32:47]
    v_mfma_f32_32x32x16_bf16 v[16:31], v[104:107], v[108:111], v[16:31]
    v_mfma_f32_32x32x16_bf16 v[32:47], v[104:107], v[112:115], v[32:47]
    v_mfma_f32_32x32x16_bf16 v[16:31], v[116:119], v[120:123], v[16:31]
    v_mfma_f32_32x32x16_bf16 v[32:47], v[116:119], v[124:127], v[32:47]
    v_cmp_gt_u32 vcc, 32, v1
    s_nop 7
    s_nop 7
    v_cndmask_b32 v8, v32, v16, vcc
    v_mul_f32 v8, 0xbfb8aa3b, v8
    v_exp_f32 v8, v8
    s_nop 0
    v_add_f32 v8, 1.0, v8
    v_rcp_f32 v8, v8
    s_nop 0
    s_branch L_f1w
L_f1n:
L_f1w:
L_lw_20004:
    ds_read_b32 v3, v13 offset:32
    s_waitcnt lgkmcnt(0)
    v_readfirstlane_b32 s5, v3
    s_cmp_eq_u32 s5, 3
    s_cbranch_scc1 L_lwd_20005
    s_sleep 4
    s_add_u32 s83, s83, 1
    s_cmp_lt_u32 s83, 200000
    s_cbranch_scc1 L_lw_20004
    s_endpgm
L_lwd_20005:
    buffer_load_dword v164, v165, s[36:39], s77 offen sc1
L_f1done:
    s_setprio 3
    s_mov_b64 exec, 1
    v_mov_b32 v3, 1
    ds_add_u32 v13, v3 offset:180
    s_mov_b64 exec, -1
    s_mov_b32 s32, s36
    s_mov_b32 s33, s37
    s_cmp_eq_u32 s85, 0
    s_cselect_b32 s34, 0x2000000, 0
    s_mov_b32 s60, s36
    s_mov_b32 s61, s37
    s_cmp_eq_u32 s85, 1
    s_cselect_b32 s62, 0x2000000, 0
    s_nop 5
    s_lshl_b32 s5, s41, 17
    s_lshl_b32 s52, s43, 12
    s_add_u32 s53, s5, s52
    s_add_u32 s53, s53, 2097152
    s_lshl_b32 s58, s86, 8
    s_add_u32 s58, s58, 13762560
    v_lshlrev_b32 v9, 2, v1
    s_nop 3
    v_cvt_pk_bf16_f32 v80, v16, v17
    v_cvt_pk_bf16_f32 v81, v18, v19
    v_cvt_pk_bf16_f32 v82, v20, v21
    v_cvt_pk_bf16_f32 v83, v22, v23
    v_cvt_pk_bf16_f32 v84, v24, v25
    v_cvt_pk_bf16_f32 v85, v26, v27
    v_cvt_pk_bf16_f32 v86, v28, v29
    v_cvt_pk_bf16_f32 v87, v30, v31
    v_pk_max_i16 v80, v80, 0
    v_pk_max_i16 v81, v81, 0
    v_pk_max_i16 v82, v82, 0
    v_pk_max_i16 v83, v83, 0
    v_pk_max_i16 v84, v84, 0
    v_pk_max_i16 v85, v85, 0
    v_pk_max_i16 v86, v86, 0
    v_pk_max_i16 v87, v87, 0
    v_cvt_pk_bf16_f32 v88, v32, v33
    v_cvt_pk_bf16_f32 v89, v34, v35
    v_cvt_pk_bf16_f32 v90, v36, v37
    v_cvt_pk_bf16_f32 v91, v38, v39
    v_cvt_pk_bf16_f32 v92, v40, v41
    v_cvt_pk_bf16_f32 v93, v42, v43
    v_cvt_pk_bf16_f32 v94, v44, v45
    v_cvt_pk_bf16_f32 v95, v46, v47
    v_pk_max_i16 v88, v88, 0
    v_pk_max_i16 v89, v89, 0
    v_pk_max_i16 v90, v90, 0
    v_pk_max_i16 v91, v91, 0
    v_pk_max_i16 v92, v92, 0
    v_pk_max_i16 v93, v93, 0
    v_pk_max_i16 v94, v94, 0
    v_pk_max_i16 v95, v95, 0
    v_cvt_pk_bf16_f32 v96, v48, v49
    v_cvt_pk_bf16_f32 v97, v50, v51
    v_cvt_pk_bf16_f32 v98, v52, v53
    v_cvt_pk_bf16_f32 v99, v54, v55
    v_cvt_pk_bf16_f32 v100, v56, v57
    v_cvt_pk_bf16_f32 v101, v58, v59
    v_cvt_pk_bf16_f32 v102, v60, v61
    v_cvt_pk_bf16_f32 v103, v62, v63
    v_pk_max_i16 v96, v96, 0
    v_pk_max_i16 v97, v97, 0
    v_pk_max_i16 v98, v98, 0
    v_pk_max_i16 v99, v99, 0
    v_pk_max_i16 v100, v100, 0
    v_pk_max_i16 v101, v101, 0
    v_pk_max_i16 v102, v102, 0
    v_pk_max_i16 v103, v103, 0
    v_cvt_pk_bf16_f32 v104, v64, v65
    v_cvt_pk_bf16_f32 v105, v66, v67
    v_cvt_pk_bf16_f32 v106, v68, v69
    v_cvt_pk_bf16_f32 v107, v70, v71
    v_cvt_pk_bf16_f32 v108, v72, v73
    v_cvt_pk_bf16_f32 v109, v74, v75
    v_cvt_pk_bf16_f32 v110, v76, v77
    v_cvt_pk_bf16_f32 v111, v78, v79
    v_pk_max_i16 v104, v104, 0
    v_pk_max_i16 v105, v105, 0
    v_pk_max_i16 v106, v106, 0
    v_pk_max_i16 v107, v107, 0
    v_pk_max_i16 v108, v108, 0
    v_pk_max_i16 v109, v109, 0
    v_pk_max_i16 v110, v110, 0
    v_pk_max_i16 v111, v111, 0
    s_waitcnt vmcnt(0)
    v_cmp_ne_u32 vcc, s82, v164
    s_cmp_eq_u64 vcc, 0
    s_cbranch_scc1 L_allok
L_poll_20006:
    buffer_load_dword v164, v165, s[36:39], s77 offen offset:0 sc1
    s_waitcnt vmcnt(0)
    v_xor_b32 v164, s82, v164
    v_cmp_ne_u32 vcc, 0, v164
    s_cmp_eq_u64 vcc, 0
    s_cbranch_scc1 L_pdone_20007
    s_sleep 3
    s_add_u32 s83, s83, 1
    s_cmp_lt_u32 s83, 200000
    s_cbranch_scc1 L_poll_20006
    s_endpgm
L_pdone_20007:
L_allok:
L_lw_20008:
    ds_read_b32 v3, v13 offset:176
    s_waitcnt lgkmcnt(0)
    v_readfirstlane_b32 s5, v3
    s_cmp_eq_u32 s5, 8
    s_cbranch_scc1 L_lwd_20009
    s_sleep 1
    s_add_u32 s83, s83, 1
    s_cmp_lt_u32 s83, 200000
    s_cbranch_scc1 L_lw_20008
    s_endpgm
L_lwd_20009:
L_lw_20010:
    ds_read_b32 v3, v13 offset:180
    s_waitcnt lgkmcnt(0)
    v_readfirstlane_b32 s5, v3
    s_cmp_eq_u32 s5, 4
    s_cbranch_scc1 L_lwd_20011
    s_sleep 1
    s_add_u32 s83, s83, 1
    s_cmp_lt_u32 s83, 200000
    s_cbranch_scc1 L_lw_20010
    s_endpgm
L_lwd_20011:
L_lw_20012:
    ds_read_b32 v3, v13 offset:188
    s_waitcnt lgkmcnt(0)
    v_readfirstlane_b32 s5, v3
    s_cmp_eq_u32 s5, 4
    s_cbranch_scc1 L_lwd_20013
    s_sleep 1
    s_add_u32 s83, s83, 1
    s_cmp_lt_u32 s83, 200000
    s_cbranch_scc1 L_lw_20012
    s_endpgm
L_lwd_20013:
    s_add_u32 s6, s72, 2
    s_and_b32 s6, s6, 7
    s_lshl_b32 s6, s6, 14
    s_add_u32 m0, s52, 32768
    s_add_u32 s6, s6, s53
    buffer_load_dwordx4 v2, s[36:39], s6 offen offset:0 sc1 lds
    buffer_load_dwordx4 v2, s[36:39], s6 offen offset:1024 sc1 lds
    buffer_load_dwordx4 v2, s[36:39], s6 offen offset:2048 sc1 lds
    buffer_load_dwordx4 v2, s[36:39], s6 offen offset:3072 sc1 lds
    s_add_u32 s6, s72, 3
    s_and_b32 s6, s6, 7
    s_lshl_b32 s6, s6, 14
    s_add_u32 m0, s52, 49152
    s_add_u32 s6, s6, s53
    buffer_load_dwordx4 v2, s[36:39], s6 offen offset:0 sc1 lds
    buffer_load_dwordx4 v2, s[36:39], s6 offen offset:1024 sc1 lds
    buffer_load_dwordx4 v2, s[36:39], s6 offen offset:2048 sc1 lds
    buffer_load_dwordx4 v2, s[36:39], s6 offen offset:3072 sc1 lds
    s_add_u32 s6, s72, 4
    s_and_b32 s6, s6, 7
    s_lshl_b32 s6, s6, 14
    s_add_u32 m0, s52, 65536
    s_add_u32 s6, s6, s53
    buffer_load_dwordx4 v2, s[36:39], s6 offen offset:0 sc1 lds
    buffer_load_dwordx4 v2, s[36:39], s6 offen offset:1024 sc1 lds
    buffer_load_dwordx4 v2, s[36:39], s6 offen offset:2048 sc1 lds
    buffer_load_dwordx4 v2, s[36:39], s6 offen offset:3072 sc1 lds
    s_lshl_b32 s74, s4, 2
    s_add_u32 s74, s74, s43
    s_lshl_b32 s74, s74, 3
    s_add_u32 s74, s74, s3
    v_and_b32 v3, 31, v1
    v_lshrrev_b32 v4, 5, v1
    v_lshlrev_b32 v4, 12, v4
    v_lshl_add_u32 v167, v3, 2, v4
    s_and_b32 s6, s74, 7
    s_cmp_ge_u32 s74, 896
    s_cbranch_scc1 L_wo
    s_mov_b32 s44, s18
    s_and_b32 s45, s19, 0xffff
    s_mov_b32 s46, 0x1c0000
    s_mov_b32 s47, 0x20000
    s_mov_b32 s28, s18
    s_and_b32 s29, s19, 0xffff
    s_mov_b32 s30, 0x0
    s_mov_b32 s31, 0x20000
    s_lshr_b32 s7, s74, 3
    s_mov_b32 s56, 114688
    s_mov_b32 s57, 10485760
    s_branch L_rl2
L_wo:
    s_mov_b32 s44, s12
    s_and_b32 s45, s13, 0xffff
    s_mov_b32 s46, 0x80000
    s_mov_b32 s47, 0x20000
    s_mov_b32 s28, s12
    s_and_b32 s29, s13, 0xffff
    s_mov_b32 s30, 0x80000
    s_mov_b32 s31, 0x20000
    s_sub_u32 s5, s74, 896
    s_lshr_b32 s7, s5, 3
    s_lshl_b32 s7, s7, 1
    s_mov_b32 s56, 32768
    s_mov_b32 s57, 12582912
L_rl2:
    s_lshl_b32 s59, s7, 14
    s_lshl_b32 s5, s6, 7
    s_add_u32 s59, s59, s5
    s_lshl_b32 s5, s6, 1
    s_mul_i32 s5, s5, s56
    s_add_u32 s57, s57, s5
    s_lshl_b32 s5, s7, 10
    s_add_u32 s57, s57, s5
    v_bfe_u32 v3, v1, 4, 1
    v_mul_lo_u32 v3, v3, s56
    v_lshrrev_b32 v4, 5, v1
    v_lshl_add_u32 v3, v4, 9, v3
    v_and_b32 v4, 15, v1
    v_lshl_add_u32 v127, v4, 4, v3
    s_add_u32 s5, s59, 0
    buffer_load_dword v144, v167, s[44:47], s5 offen offset:0
    buffer_load_dword v145, v167, s[44:47], s5 offen offset:1024
    buffer_load_dword v146, v167, s[44:47], s5 offen offset:2048
    buffer_load_dword v147, v167, s[44:47], s5 offen offset:3072
    s_add_u32 s5, s59, 8192
    buffer_load_dword v148, v167, s[44:47], s5 offen offset:0
    buffer_load_dword v149, v167, s[44:47], s5 offen offset:1024
    buffer_load_dword v150, v167, s[44:47], s5 offen offset:2048
    buffer_load_dword v151, v167, s[44:47], s5 offen offset:3072
    s_add_u32 s5, s59, 16384
    buffer_load_dword v152, v167, s[28:31], s5 offen offset:0
    buffer_load_dword v153, v167, s[28:31], s5 offen offset:1024
    buffer_load_dword v154, v167, s[28:31], s5 offen offset:2048
    buffer_load_dword v155, v167, s[28:31], s5 offen offset:3072
    s_add_u32 s5, s59, 24576
    buffer_load_dword v156, v167, s[28:31], s5 offen offset:0
    buffer_load_dword v157, v167, s[28:31], s5 offen offset:1024
    buffer_load_dword v158, v167, s[28:31], s5 offen offset:2048
    buffer_load_dword v159, v167, s[28:31], s5 offen offset:3072
    buffer_store_dwordx4 v[80:83], v2, s[32:35], s54 offen offset:0 sc1
    buffer_store_dwordx4 v[84:87], v2, s[32:35], s54 offen offset:1024 sc1
    buffer_store_dwordx4 v[88:91], v2, s[32:35], s55 offen offset:0 sc1
    buffer_store_dwordx4 v[92:95], v2, s[32:35], s55 offen offset:1024 sc1
    buffer_store_dwordx4 v[96:99], v2, s[32:35], s54 offen offset:2048 sc1
    buffer_store_dwordx4 v[100:103], v2, s[32:35], s54 offen offset:3072 sc1
    buffer_store_dwordx4 v[104:107], v2, s[32:35], s55 offen offset:2048 sc1
    buffer_store_dwordx4 v[108:111], v2, s[32:35], s55 offen offset:3072 sc1
    buffer_store_dword v8, v9, s[60:63], s58 offen sc1
    s_mov_b32 s28, s36
    s_mov_b32 s29, s37
    s_cmp_ge_u32 s74, 896
    s_cselect_b32 s30, 0x2000000, 0
    s_mov_b32 s80, 0x05040100
    s_mov_b32 s81, 0x07060302
    s_waitcnt vmcnt(25)
    v_mov_b32 v10, 5
    ds_write_b32 v166, v10 offset:0
    s_waitcnt vmcnt(9)
    v_perm_b32 v128, v145, v144, s80
    v_perm_b32 v132, v145, v144, s81
    v_perm_b32 v129, v147, v146, s80
    v_perm_b32 v133, v147, v146, s81
    v_perm_b32 v130, v149, v148, s80
    v_perm_b32 v134, v149, v148, s81
    v_perm_b32 v131, v151, v150, s80
    v_perm_b32 v135, v151, v150, s81
    buffer_store_dwordx4 v[128:131], v127, s[36:39], s57 offen offset:0 sc1
    buffer_store_dwordx4 v[132:135], v127, s[36:39], s57 offen offset:256 sc1
    v_perm_b32 v136, v153, v152, s80
    v_perm_b32 v140, v153, v152, s81
    v_perm_b32 v137, v155, v154, s80
    v_perm_b32 v141, v155, v154, s81
    v_perm_b32 v138, v157, v156, s80
    v_perm_b32 v142, v157, v156, s81
    v_perm_b32 v139, v159, v158, s80
    v_perm_b32 v143, v159, v158, s81
    buffer_store_dwordx4 v[136:139], v127, s[28:31], s57 offen offset:1024 sc1
    buffer_store_dwordx4 v[140:143], v127, s[28:31], s57 offen offset:1280 sc1
    s_add_u32 s6, s72, 5
    s_and_b32 s6, s6, 7
    s_lshl_b32 s6, s6, 14
    s_add_u32 m0, s52, 81920
    s_add_u32 s6, s6, s53
    buffer_load_dwordx4 v2, s[36:39], s6 offen offset:0 sc1 lds
    buffer_load_dwordx4 v2, s[36:39], s6 offen offset:1024 sc1 lds
    buffer_load_dwordx4 v2, s[36:39], s6 offen offset:2048 sc1 lds
    buffer_load_dwordx4 v2, s[36:39], s6 offen offset:3072 sc1 lds
    s_add_u32 s6, s72, 6
    s_and_b32 s6, s6, 7
    s_lshl_b32 s6, s6, 14
    s_add_u32 m0, s52, 98304
    s_add_u32 s6, s6, s53
    buffer_load_dwordx4 v2, s[36:39], s6 offen offset:0 sc1 lds
    buffer_load_dwordx4 v2, s[36:39], s6 offen offset:1024 sc1 lds
    buffer_load_dwordx4 v2, s[36:39], s6 offen offset:2048 sc1 lds
    buffer_load_dwordx4 v2, s[36:39], s6 offen offset:3072 sc1 lds
    s_add_u32 s6, s72, 7
    s_and_b32 s6, s6, 7
    s_lshl_b32 s6, s6, 14
    s_add_u32 m0, s52, 114688
    s_add_u32 s6, s6, s53
    buffer_load_dwordx4 v2, s[36:39], s6 offen offset:0 sc1 lds
    buffer_load_dwordx4 v2, s[36:39], s6 offen offset:1024 sc1 lds
    buffer_load_dwordx4 v2, s[36:39], s6 offen offset:2048 sc1 lds
    buffer_load_dwordx4 v2, s[36:39], s6 offen offset:3072 sc1 lds
    s_waitcnt vmcnt(12)
    s_mov_b64 exec, 1
    v_mov_b32 v8, 1
    ds_add_rtn_u32 v8, v13, v8 offset:140
    s_waitcnt lgkmcnt(0)
    s_mov_b64 exec, -1
    v_readfirstlane_b32 s5, v8
    s_cmp_lg_u32 s5, 3
    s_cbranch_scc1 L_e2skip
    s_lshl_b32 s5, s2, 7
    s_add_u32 s5, s5, 13697024
    s_mov_b64 exec, 0xff
    v_mov_b32 v80, s82
    v_mov_b32 v81, s82
    v_mov_b32 v82, s82
    v_mov_b32 v83, s82
    buffer_store_dwordx4 v[80:83], v2, s[36:39], s5 offen sc1
    s_mov_b64 exec, -1
    s_nop 1
L_e2skip:
    s_waitcnt vmcnt(0)
    v_mov_b32 v10, 8
    ds_write_b32 v166, v10 offset:0
    s_mul_i32 s5, s43, 7
    s_lshl_b32 s50, 0x7f, s5
    s_lshl_b32 s5, 0x10000000, s43
    s_or_b32 s50, s50, s5
    s_lshl_b32 s5, s43, 1
    s_lshl_b32 s51, 3, s5
    s_lshl_b32 s5, 0x100, s43
    s_or_b32 s51, s51, s5
    v_and_b32 v3, 7, v1
    s_lshl_b32 s5, s42, 2
    v_add_u32 v4, s5, v3
    v_mov_b32 v5, s41
    v_cmp_lt_u32 vcc, 39, v1
    v_cndmask_b32 v4, v5, v4, vcc
    v_cndmask_b32 v3, v3, 1, vcc
    v_lshrrev_b32 v5, 3, v4
    v_lshlrev_b32 v5, 1, v5
    v_and_b32 v6, 1, v3
    v_add_u32 v5, v5, v6
    v_lshrrev_b32 v6, 1, v3
    v_lshlrev_b32 v6, 3, v6
    v_and_b32 v4, 7, v4
    v_add_u32 v6, v6, v4
    v_lshl_add_u32 v4, v6, 3, v5
    v_lshlrev_b32 v7, 3, v1
    v_add_u32 v7, s42, v7
    v_cmp_lt_u32 vcc, 31, v1
    v_cndmask_b32 v7, v7, v4, vcc
    v_lshlrev_b32 v7, 7, v7
    s_mov_b32 s58, 13697024
L_lw_20014:
    ds_read_b32 v6, v13 offset:140
    s_waitcnt lgkmcnt(0)
    v_readfirstlane_b32 s5, v6
    s_cmp_eq_u32 s5, 4
    s_cbranch_scc1 L_lwd_20015
    s_sleep 4
    s_add_u32 s83, s83, 1
    s_cmp_lt_u32 s83, 200000
    s_cbranch_scc1 L_lw_20014
    s_endpgm
L_lwd_20015:
L_e2p:
    s_mov_b64 exec, s[50:51]
    buffer_load_dword v80, v7, s[36:39], s58 offen sc1
    s_waitcnt vmcnt(0)
    v_cmp_ne_u32 vcc, s82, v80
    s_mov_b64 exec, -1
    s_cmp_eq_u64 vcc, 0
    s_cbranch_scc1 L_e2ok
    s_sleep 10
    s_add_u32 s83, s83, 1
    s_cmp_lt_u32 s83, 200000
    s_cbranch_scc1 L_e2p
    s_endpgm
L_e2ok:
    v_and_b32 v3, 31, v1
    v_lshlrev_b32 v3, 2, v3
    s_lshl_b32 s58, s41, 8
    s_and_b32 s5, s43, 1
    s_lshl_b32 s5, s5, 7
    s_add_u32 s58, s58, s5
    s_add_u32 s58, s58, 13762560
    v_mov_b32 v10, v3
    s_lshl_b32 s5, s42, 3
    s_lshl_b32 s6, s43, 1
    s_add_u32 s5, s5, s6
    s_lshl_b32 s5, s5, 5
    s_add_u32 s5, s5, s41
    s_lshl_b32 s5, s5, 10
    s_add_u32 s5, s5, 25165824
    s_add_u32 s6, s5, 32768
    v_mov_b32 v160, -1
    v_mov_b32 v161, -1
    v_mov_b32 v162, -1
    v_mov_b32 v163, -1
    buffer_store_dwordx4 v[160:163], v2, s[36:39], s5 offen sc1
    buffer_store_dwordx4 v[160:163], v2, s[36:39], s6 offen sc1
    s_lshr_b32 s50, s43, 1
    s_and_b32 s51, s43, 1
    s_mul_i32 s5, s50, 114688
    v_add_u32 v4, s5, v2
    s_sub_u32 s5, 114688, s5
    v_add_u32 v5, s5, v2
    s_mul_i32 s5, s51, 114688
    v_add_u32 v6, s5, v2
    s_sub_u32 s5, 114688, s5
    v_add_u32 v7, s5, v2
    s_mul_i32 s5, s43, 28672
    s_mul_i32 s52, s42, 229376
    s_add_u32 s52, s52, s5
    s_add_u32 s52, s52, 10485760
    s_mul_i32 s53, s41, 229376
    s_add_u32 s53, s53, s5
    s_add_u32 s53, s53, 16777216
    s_lshl_b32 s54, s42, 1
    s_lshr_b32 s5, s43, 1
    s_add_u32 s54, s54, s5
    s_lshl_b32 s54, s54, 15
    s_add_u32 s54, s54, 12582912
    s_lshl_b32 s55, s41, 1
    s_and_b32 s5, s43, 1
    s_add_u32 s55, s55, s5
    s_lshl_b32 s56, s55, 12
    s_add_u32 s56, s56, 14155776
    s_lshl_b32 s55, s55, 15
    s_add_u32 s55, s55, 25165824
    s_sub_u32 s78, s73, 7
    s_cmp_ge_u32 s73, 7
    s_cselect_b32 s78, s78, s73
    s_setprio 0
    s_lshl_b32 s5, s78, 12
    s_add_u32 s80, s52, s5
    s_add_u32 s81, s53, s5
    s_lshl_b32 s79, s78, 7
    s_add_u32 s78, s78, 1
    s_cmp_eq_u32 s78, 7
    s_cselect_b32 s78, 0, s78
    buffer_load_dwordx4 v[80:83], v4, s[36:39], s80 offen offset:0 sc1
    buffer_load_dwordx4 v[84:87], v5, s[36:39], s80 offen offset:0 sc1
    buffer_load_dwordx4 v[88:91], v6, s[36:39], s81 offen offset:0 sc1
    buffer_load_dwordx4 v[92:95], v7, s[36:39], s81 offen offset:0 sc1
    buffer_load_dwordx4 v[96:99], v4, s[36:39], s80 offen offset:1024 sc1
    buffer_load_dwordx4 v[100:103], v5, s[36:39], s80 offen offset:1024 sc1
    buffer_load_dwordx4 v[104:107], v6, s[36:39], s81 offen offset:1024 sc1
    buffer_load_dwordx4 v[108:111], v7, s[36:39], s81 offen offset:1024 sc1
    buffer_load_dwordx4 v[112:115], v4, s[36:39], s80 offen offset:2048 sc1
    buffer_load_dwordx4 v[116:119], v5, s[36:39], s80 offen offset:2048 sc1
    buffer_load_dwordx4 v[120:123], v6, s[36:39], s81 offen offset:2048 sc1
    buffer_load_dwordx4 v[124:127], v7, s[36:39], s81 offen offset:2048 sc1
    buffer_load_dwordx4 v[128:131], v4, s[36:39], s80 offen offset:3072 sc1
    buffer_load_dwordx4 v[132:135], v5, s[36:39], s80 offen offset:3072 sc1
    buffer_load_dwordx4 v[136:139], v6, s[36:39], s81 offen offset:3072 sc1
    buffer_load_dwordx4 v[140:143], v7, s[36:39], s81 offen offset:3072 sc1
    s_lshl_b32 s5, s78, 12
    s_add_u32 s80, s52, s5
    s_add_u32 s81, s53, s5
    s_lshl_b32 s79, s78, 7
    s_add_u32 s78, s78, 1
    s_cmp_eq_u32 s78, 7
    s_cselect_b32 s78, 0, s78
    buffer_load_dwordx4 v[144:147], v4, s[36:39], s80 offen offset:0 sc1
    buffer_load_dwordx4 v[148:151], v5, s[36:39], s80 offen offset:0 sc1
    buffer_load_dwordx4 v[152:155], v6, s[36:39], s81 offen offset:0 sc1
    buffer_load_dwordx4 v[156:159], v7, s[36:39], s81 offen offset:0 sc1
    s_waitcnt vmcnt(16)
    v_mfma_f32_32x32x16_bf16 v[16:31], v[80:83], v[88:91], 0
    v_mfma_f32_32x32x16_bf16 v[32:47], v[80:83], v[92:95], 0
    v_mfma_f32_32x32x16_bf16 v[48:63], v[84:87], v[88:91], 0
    v_mfma_f32_32x32x16_bf16 v[64:79], v[84:87], v[92:95], 0
    buffer_load_dwordx4 v[80:83], v4, s[36:39], s80 offen offset:1024 sc1
    buffer_load_dwordx4 v[84:87], v5, s[36:39], s80 offen offset:1024 sc1
    buffer_load_dwordx4 v[88:91], v6, s[36:39], s81 offen offset:1024 sc1
    buffer_load_dwordx4 v[92:95], v7, s[36:39], s81 offen offset:1024 sc1
    s_waitcnt vmcnt(16)
    s_mov_b64 exec, 1
    v_mov_b32 v9, 1
    ds_add_u32 v13, v9 offset:216
    s_mov_b64 exec, -1
    v_mfma_f32_32x32x16_bf16 v[16:31], v[96:99], v[104:107], v[16:31]
    v_mfma_f32_32x32x16_bf16 v[32:47], v[96:99], v[108:111], v[32:47]
    v_mfma_f32_32x32x16_bf16 v[48:63], v[100:103], v[104:107], v[48:63]
    v_mfma_f32_32x32x16_bf16 v[64:79], v[100:103], v[108:111], v[64:79]
    buffer_load_dwordx4 v[96:99], v4, s[36:39], s80 offen offset:2048 sc1
    buffer_load_dwordx4 v[100:103], v5, s[36:39], s80 offen offset:2048 sc1
    buffer_load_dwordx4 v[104:107], v6, s[36:39], s81 offen offset:2048 sc1
    buffer_load_dwordx4 v[108:111], v7, s[36:39], s81 offen offset:2048 sc1
    s_waitcnt vmcnt(16)
    v_mfma_f32_32x32x16_bf16 v[16:31], v[112:115], v[120:123], v[16:31]
    v_mfma_f32_32x32x16_bf16 v[32:47], v[112:115], v[124:127], v[32:47]
    v_mfma_f32_32x32x16_bf16 v[48:63], v[116:119], v[120:123], v[48:63]
    v_mfma_f32_32x32x16_bf16 v[64:79], v[116:119], v[124:127], v[64:79]
    buffer_load_dwordx4 v[112:115], v4, s[36:39], s80 offen offset:3072 sc1
    buffer_load_dwordx4 v[116:119], v5, s[36:39], s80 offen offset:3072 sc1
    buffer_load_dwordx4 v[120:123], v6, s[36:39], s81 offen offset:3072 sc1
    buffer_load_dwordx4 v[124:127], v7, s[36:39], s81 offen offset:3072 sc1
    s_waitcnt vmcnt(16)
    v_mfma_f32_32x32x16_bf16 v[16:31], v[128:131], v[136:139], v[16:31]
    v_mfma_f32_32x32x16_bf16 v[32:47], v[128:131], v[140:143], v[32:47]
    v_mfma_f32_32x32x16_bf16 v[48:63], v[132:135], v[136:139], v[48:63]
    v_mfma_f32_32x32x16_bf16 v[64:79], v[132:135], v[140:143], v[64:79]
    s_lshl_b32 s5, s78, 12
    s_add_u32 s80, s52, s5
    s_add_u32 s81, s53, s5
    s_lshl_b32 s79, s78, 7
    s_add_u32 s78, s78, 1
    s_cmp_eq_u32 s78, 7
    s_cselect_b32 s78, 0, s78
    buffer_load_dwordx4 v[128:131], v4, s[36:39], s80 offen offset:0 sc1
    buffer_load_dwordx4 v[132:135], v5, s[36:39], s80 offen offset:0 sc1
    buffer_load_dwordx4 v[136:139], v6, s[36:39], s81 offen offset:0 sc1
    buffer_load_dwordx4 v[140:143], v7, s[36:39], s81 offen offset:0 sc1
    s_waitcnt vmcnt(16)
    v_mfma_f32_32x32x16_bf16 v[16:31], v[144:147], v[152:155], v[16:31]
    v_mfma_f32_32x32x16_bf16 v[32:47], v[144:147], v[156:159], v[32:47]
    v_mfma_f32_32x32x16_bf16 v[48:63], v[148:151], v[152:155], v[48:63]
    v_mfma_f32_32x32x16_bf16 v[64:79], v[148:151], v[156:159], v[64:79]
    buffer_load_dwordx4 v[144:147], v4, s[36:39], s80 offen offset:1024 sc1
    buffer_load_dwordx4 v[148:151], v5, s[36:39], s80 offen offset:1024 sc1
    buffer_load_dwordx4 v[152:155], v6, s[36:39], s81 offen offset:1024 sc1
    buffer_load_dwordx4 v[156:159], v7, s[36:39], s81 offen offset:1024 sc1
    s_waitcnt vmcnt(16)
    v_mfma_f32_32x32x16_bf16 v[16:31], v[80:83], v[88:91], v[16:31]
    v_mfma_f32_32x32x16_bf16 v[32:47], v[80:83], v[92:95], v[32:47]
    v_mfma_f32_32x32x16_bf16 v[48:63], v[84:87], v[88:91], v[48:63]
    v_mfma_f32_32x32x16_bf16 v[64:79], v[84:87], v[92:95], v[64:79]
    buffer_load_dwordx4 v[80:83], v4, s[36:39], s80 offen offset:2048 sc1
    buffer_load_dwordx4 v[84:87], v5, s[36:39], s80 offen offset:2048 sc1
    buffer_load_dwordx4 v[88:91], v6, s[36:39], s81 offen offset:2048 sc1
    buffer_load_dwordx4 v[92:95], v7, s[36:39], s81 offen offset:2048 sc1
    s_waitcnt vmcnt(16)
    v_mfma_f32_32x32x16_bf16 v[16:31], v[96:99], v[104:107], v[16:31]
    v_mfma_f32_32x32x16_bf16 v[32:47], v[96:99], v[108:111], v[32:47]
    v_mfma_f32_32x32x16_bf16 v[48:63], v[100:103], v[104:107], v[48:63]
    v_mfma_f32_32x32x16_bf16 v[64:79], v[100:103], v[108:111], v[64:79]
    buffer_load_dwordx4 v[96:99], v4, s[36:39], s80 offen offset:3072 sc1
    buffer_load_dwordx4 v[100:103], v5, s[36:39], s80 offen offset:3072 sc1
    buffer_load_dwordx4 v[104:107], v6, s[36:39], s81 offen offset:3072 sc1
    buffer_load_dwordx4 v[108:111], v7, s[36:39], s81 offen offset:3072 sc1
    s_waitcnt vmcnt(16)
    v_mfma_f32_32x32x16_bf16 v[16:31], v[112:115], v[120:123], v[16:31]
    v_mfma_f32_32x32x16_bf16 v[32:47], v[112:115], v[124:127], v[32:47]
    v_mfma_f32_32x32x16_bf16 v[48:63], v[116:119], v[120:123], v[48:63]
    v_mfma_f32_32x32x16_bf16 v[64:79], v[116:119], v[124:127], v[64:79]
    s_lshl_b32 s5, s78, 12
    s_add_u32 s80, s52, s5
    s_add_u32 s81, s53, s5
    s_lshl_b32 s79, s78, 7
    s_add_u32 s78, s78, 1
    s_cmp_eq_u32 s78, 7
    s_cselect_b32 s78, 0, s78
    buffer_load_dwordx4 v[112:115], v4, s[36:39], s80 offen offset:0 sc1
    buffer_load_dwordx4 v[116:119], v5, s[36:39], s80 offen offset:0 sc1
    buffer_load_dwordx4 v[120:123], v6, s[36:39], s81 offen offset:0 sc1
    buffer_load_dwordx4 v[124:127], v7, s[36:39], s81 offen offset:0 sc1
    s_waitcnt vmcnt(16)
    v_mfma_f32_32x32x16_bf16 v[16:31], v[128:131], v[136:139], v[16:31]
    v_mfma_f32_32x32x16_bf16 v[32:47], v[128:131], v[140:143], v[32:47]
    v_mfma_f32_32x32x16_bf16 v[48:63], v[132:135], v[136:139], v[48:63]
    v_mfma_f32_32x32x16_bf16 v[64:79], v[132:135], v[140:143], v[64:79]
    buffer_load_dwordx4 v[128:131], v4, s[36:39], s80 offen offset:1024 sc1
    buffer_load_dwordx4 v[132:135], v5, s[36:39], s80 offen offset:1024 sc1
    buffer_load_dwordx4 v[136:139], v6, s[36:39], s81 offen offset:1024 sc1
    buffer_load_dwordx4 v[140:143], v7, s[36:39], s81 offen offset:1024 sc1
    s_waitcnt vmcnt(16)
    v_mfma_f32_32x32x16_bf16 v[16:31], v[144:147], v[152:155], v[16:31]
    v_mfma_f32_32x32x16_bf16 v[32:47], v[144:147], v[156:159], v[32:47]
    v_mfma_f32_32x32x16_bf16 v[48:63], v[148:151], v[152:155], v[48:63]
    v_mfma_f32_32x32x16_bf16 v[64:79], v[148:151], v[156:159], v[64:79]
    buffer_load_dwordx4 v[144:147], v4, s[36:39], s80 offen offset:2048 sc1
    buffer_load_dwordx4 v[148:151], v5, s[36:39], s80 offen offset:2048 sc1
    buffer_load_dwordx4 v[152:155], v6, s[36:39], s81 offen offset:2048 sc1
    buffer_load_dwordx4 v[156:159], v7, s[36:39], s81 offen offset:2048 sc1
    s_waitcnt vmcnt(16)
    v_mfma_f32_32x32x16_bf16 v[16:31], v[80:83], v[88:91], v[16:31]
    v_mfma_f32_32x32x16_bf16 v[32:47], v[80:83], v[92:95], v[32:47]
    v_mfma_f32_32x32x16_bf16 v[48:63], v[84:87], v[88:91], v[48:63]
    v_mfma_f32_32x32x16_bf16 v[64:79], v[84:87], v[92:95], v[64:79]
    buffer_load_dwordx4 v[80:83], v4, s[36:39], s80 offen offset:3072 sc1
    buffer_load_dwordx4 v[84:87], v5, s[36:39], s80 offen offset:3072 sc1
    buffer_load_dwordx4 v[88:91], v6, s[36:39], s81 offen offset:3072 sc1
    buffer_load_dwordx4 v[92:95], v7, s[36:39], s81 offen offset:3072 sc1
    s_waitcnt vmcnt(16)
    v_mfma_f32_32x32x16_bf16 v[16:31], v[96:99], v[104:107], v[16:31]
    v_mfma_f32_32x32x16_bf16 v[32:47], v[96:99], v[108:111], v[32:47]
    v_mfma_f32_32x32x16_bf16 v[48:63], v[100:103], v[104:107], v[48:63]
    v_mfma_f32_32x32x16_bf16 v[64:79], v[100:103], v[108:111], v[64:79]
    s_lshl_b32 s5, s78, 12
    s_add_u32 s80, s52, s5
    s_add_u32 s81, s53, s5
    s_lshl_b32 s79, s78, 7
    s_add_u32 s78, s78, 1
    s_cmp_eq_u32 s78, 7
    s_cselect_b32 s78, 0, s78
    buffer_load_dwordx4 v[96:99], v4, s[36:39], s80 offen offset:0 sc1
    buffer_load_dwordx4 v[100:103], v5, s[36:39], s80 offen offset:0 sc1
    buffer_load_dwordx4 v[104:107], v6, s[36:39], s81 offen offset:0 sc1
    buffer_load_dwordx4 v[108:111], v7, s[36:39], s81 offen offset:0 sc1
    s_waitcnt vmcnt(16)
    v_mfma_f32_32x32x16_bf16 v[16:31], v[112:115], v[120:123], v[16:31]
    v_mfma_f32_32x32x16_bf16 v[32:47], v[112:115], v[124:127], v[32:47]
    v_mfma_f32_32x32x16_bf16 v[48:63], v[116:119], v[120:123], v[48:63]
    v_mfma_f32_32x32x16_bf16 v[64:79], v[116:119], v[124:127], v[64:79]
    buffer_load_dwordx4 v[112:115], v4, s[36:39], s80 offen offset:1024 sc1
    buffer_load_dwordx4 v[116:119], v5, s[36:39], s80 offen offset:1024 sc1
    buffer_load_dwordx4 v[120:123], v6, s[36:39], s81 offen offset:1024 sc1
    buffer_load_dwordx4 v[124:127], v7, s[36:39], s81 offen offset:1024 sc1
    s_waitcnt vmcnt(16)
    v_mfma_f32_32x32x16_bf16 v[16:31], v[128:131], v[136:139], v[16:31]
    v_mfma_f32_32x32x16_bf16 v[32:47], v[128:131], v[140:143], v[32:47]
    v_mfma_f32_32x32x16_bf16 v[48:63], v[132:135], v[136:139], v[48:63]
    v_mfma_f32_32x32x16_bf16 v[64:79], v[132:135], v[140:143], v[64:79]
    buffer_load_dwordx4 v[128:131], v4, s[36:39], s80 offen offset:2048 sc1
    buffer_load_dwordx4 v[132:135], v5, s[36:39], s80 offen offset:2048 sc1
    buffer_load_dwordx4 v[136:139], v6, s[36:39], s81 offen offset:2048 sc1
    buffer_load_dwordx4 v[140:143], v7, s[36:39], s81 offen offset:2048 sc1
    s_waitcnt vmcnt(16)
    v_mfma_f32_32x32x16_bf16 v[16:31], v[144:147], v[152:155], v[16:31]
    v_mfma_f32_32x32x16_bf16 v[32:47], v[144:147], v[156:159], v[32:47]
    v_mfma_f32_32x32x16_bf16 v[48:63], v[148:151], v[152:155], v[48:63]
    v_mfma_f32_32x32x16_bf16 v[64:79], v[148:151], v[156:159], v[64:79]
    buffer_load_dwordx4 v[144:147], v4, s[36:39], s80 offen offset:3072 sc1
    buffer_load_dwordx4 v[148:151], v5, s[36:39], s80 offen offset:3072 sc1
    buffer_load_dwordx4 v[152:155], v6, s[36:39], s81 offen offset:3072 sc1
    buffer_load_dwordx4 v[156:159], v7, s[36:39], s81 offen offset:3072 sc1
    s_waitcnt vmcnt(16)
    v_mfma_f32_32x32x16_bf16 v[16:31], v[80:83], v[88:91], v[16:31]
    v_mfma_f32_32x32x16_bf16 v[32:47], v[80:83], v[92:95], v[32:47]
    v_mfma_f32_32x32x16_bf16 v[48:63], v[84:87], v[88:91], v[48:63]
    v_mfma_f32_32x32x16_bf16 v[64:79], v[84:87], v[92:95], v[64:79]
    s_lshl_b32 s5, s78, 12
    s_add_u32 s80, s52, s5
    s_add_u32 s81, s53, s5
    s_lshl_b32 s79, s78, 7
    s_add_u32 s78, s78, 1
    s_cmp_eq_u32 s78, 7
    s_cselect_b32 s78, 0, s78
    buffer_load_dwordx4 v[80:83], v4, s[36:39], s80 offen offset:0 sc1
    buffer_load_dwordx4 v[84:87], v5, s[36:39], s80 offen offset:0 sc1
    buffer_load_dwordx4 v[88:91], v6, s[36:39], s81 offen offset:0 sc1
    buffer_load_dwordx4 v[92:95], v7, s[36:39], s81 offen offset:0 sc1
    s_waitcnt vmcnt(16)
    v_mfma_f32_32x32x16_bf16 v[16:31], v[96:99], v[104:107], v[16:31]
    v_mfma_f32_32x32x16_bf16 v[32:47], v[96:99], v[108:111], v[32:47]
    v_mfma_f32_32x32x16_bf16 v[48:63], v[100:103], v[104:107], v[48:63]
    v_mfma_f32_32x32x16_bf16 v[64:79], v[100:103], v[108:111], v[64:79]
    buffer_load_dwordx4 v[96:99], v4, s[36:39], s80 offen offset:1024 sc1
    buffer_load_dwordx4 v[100:103], v5, s[36:39], s80 offen offset:1024 sc1
    buffer_load_dwordx4 v[104:107], v6, s[36:39], s81 offen offset:1024 sc1
    buffer_load_dwordx4 v[108:111], v7, s[36:39], s81 offen offset:1024 sc1
    s_waitcnt vmcnt(16)
    v_mfma_f32_32x32x16_bf16 v[16:31], v[112:115], v[120:123], v[16:31]
    v_mfma_f32_32x32x16_bf16 v[32:47], v[112:115], v[124:127], v[32:47]
    v_mfma_f32_32x32x16_bf16 v[48:63], v[116:119], v[120:123], v[48:63]
    v_mfma_f32_32x32x16_bf16 v[64:79], v[116:119], v[124:127], v[64:79]
    buffer_load_dwordx4 v[112:115], v4, s[36:39], s80 offen offset:2048 sc1
    buffer_load_dwordx4 v[116:119], v5, s[36:39], s80 offen offset:2048 sc1
    buffer_load_dwordx4 v[120:123], v6, s[36:39], s81 offen offset:2048 sc1
    buffer_load_dwordx4 v[124:127], v7, s[36:39], s81 offen offset:2048 sc1
    s_waitcnt vmcnt(16)
    v_mfma_f32_32x32x16_bf16 v[16:31], v[128:131], v[136:139], v[16:31]
    v_mfma_f32_32x32x16_bf16 v[32:47], v[128:131], v[140:143], v[32:47]
    v_mfma_f32_32x32x16_bf16 v[48:63], v[132:135], v[136:139], v[48:63]
    v_mfma_f32_32x32x16_bf16 v[64:79], v[132:135], v[140:143], v[64:79]
    buffer_load_dwordx4 v[128:131], v4, s[36:39], s80 offen offset:3072 sc1
    buffer_load_dwordx4 v[132:135], v5, s[36:39], s80 offen offset:3072 sc1
    buffer_load_dwordx4 v[136:139], v6, s[36:39], s81 offen offset:3072 sc1
    buffer_load_dwordx4 v[140:143], v7, s[36:39], s81 offen offset:3072 sc1
    s_waitcnt vmcnt(16)
    v_mfma_f32_32x32x16_bf16 v[16:31], v[144:147], v[152:155], v[16:31]
    v_mfma_f32_32x32x16_bf16 v[32:47], v[144:147], v[156:159], v[32:47]
    v_mfma_f32_32x32x16_bf16 v[48:63], v[148:151], v[152:155], v[48:63]
    v_mfma_f32_32x32x16_bf16 v[64:79], v[148:151], v[156:159], v[64:79]
    s_lshl_b32 s5, s78, 12
    s_add_u32 s80, s52, s5
    s_add_u32 s81, s53, s5
    s_lshl_b32 s79, s78, 7
    s_add_u32 s78, s78, 1
    s_cmp_eq_u32 s78, 7
    s_cselect_b32 s78, 0, s78
    buffer_load_dwordx4 v[144:147], v4, s[36:39], s80 offen offset:0 sc1
    buffer_load_dwordx4 v[148:151], v5, s[36:39], s80 offen offset:0 sc1
    buffer_load_dwordx4 v[152:155], v6, s[36:39], s81 offen offset:0 sc1
    buffer_load_dwordx4 v[156:159], v7, s[36:39], s81 offen offset:0 sc1
    s_waitcnt vmcnt(16)
    s_lshl_b32 s6, s43, 14
    s_lshl_b32 s7, s42, 16
    s_add_u32 s7, s7, s6
    s_add_u32 s7, s7, 12582912
L_lw_20016:
    ds_read_b32 v9, v13 offset:216
    s_waitcnt lgkmcnt(0)
    v_readfirstlane_b32 s5, v9
    s_cmp_eq_u32 s5, 4
    s_cbranch_scc1 L_lwd_20017
    s_sleep 4
    s_add_u32 s83, s83, 1
    s_cmp_lt_u32 s83, 200000
    s_cbranch_scc1 L_lw_20016
    s_endpgm
L_lwd_20017:
    buffer_load_dword v10, v10, s[36:39], s58 offen sc1
L_lw_20018:
    ds_read_b32 v9, v13 offset:192
    s_waitcnt lgkmcnt(0)
    v_readfirstlane_b32 s5, v9
    s_cmp_eq_u32 s5, 8
    s_cbranch_scc1 L_lwd_20019
    s_sleep 4
    s_add_u32 s83, s83, 1
    s_cmp_lt_u32 s83, 200000
    s_cbranch_scc1 L_lw_20018
    s_endpgm
L_lwd_20019:
    s_add_u32 m0, s6, 0
    s_add_u32 s5, s7, 0
    buffer_load_dwordx4 v2, s[36:39], s5 offen offset:0 sc1 lds
    buffer_load_dwordx4 v2, s[36:39], s5 offen offset:1024 sc1 lds
    buffer_load_dwordx4 v2, s[36:39], s5 offen offset:2048 sc1 lds
    buffer_load_dwordx4 v2, s[36:39], s5 offen offset:3072 sc1 lds
    s_add_u32 m0, s6, 4096
    s_add_u32 s5, s7, 4096
    buffer_load_dwordx4 v2, s[36:39], s5 offen offset:0 sc1 lds
    buffer_load_dwordx4 v2, s[36:39], s5 offen offset:1024 sc1 lds
    buffer_load_dwordx4 v2, s[36:39], s5 offen offset:2048 sc1 lds
    buffer_load_dwordx4 v2, s[36:39], s5 offen offset:3072 sc1 lds
    s_add_u32 m0, s6, 8192
    s_add_u32 s5, s7, 8192
    buffer_load_dwordx4 v2, s[36:39], s5 offen offset:0 sc1 lds
    buffer_load_dwordx4 v2, s[36:39], s5 offen offset:1024 sc1 lds
    buffer_load_dwordx4 v2, s[36:39], s5 offen offset:2048 sc1 lds
    buffer_load_dwordx4 v2, s[36:39], s5 offen offset:3072 sc1 lds
    s_add_u32 m0, s6, 12288
    s_add_u32 s5, s7, 12288
    buffer_load_dwordx4 v2, s[36:39], s5 offen offset:0 sc1 lds
    buffer_load_dwordx4 v2, s[36:39], s5 offen offset:1024 sc1 lds
    buffer_load_dwordx4 v2, s[36:39], s5 offen offset:2048 sc1 lds
    buffer_load_dwordx4 v2, s[36:39], s5 offen offset:3072 sc1 lds
    v_mfma_f32_32x32x16_bf16 v[16:31], v[80:83], v[88:91], v[16:31]
    v_mfma_f32_32x32x16_bf16 v[32:47], v[80:83], v[92:95], v[32:47]
    v_mfma_f32_32x32x16_bf16 v[48:63], v[84:87], v[88:91], v[48:63]
    v_mfma_f32_32x32x16_bf16 v[64:79], v[84:87], v[92:95], v[64:79]
    buffer_load_dwordx4 v[80:83], v4, s[36:39], s80 offen offset:1024 sc1
    buffer_load_dwordx4 v[84:87], v5, s[36:39], s80 offen offset:1024 sc1
    buffer_load_dwordx4 v[88:91], v6, s[36:39], s81 offen offset:1024 sc1
    buffer_load_dwordx4 v[92:95], v7, s[36:39], s81 offen offset:1024 sc1
    s_waitcnt vmcnt(33)
    v_mfma_f32_32x32x16_bf16 v[16:31], v[96:99], v[104:107], v[16:31]
    v_mfma_f32_32x32x16_bf16 v[32:47], v[96:99], v[108:111], v[32:47]
    v_mfma_f32_32x32x16_bf16 v[48:63], v[100:103], v[104:107], v[48:63]
    v_mfma_f32_32x32x16_bf16 v[64:79], v[100:103], v[108:111], v[64:79]
    buffer_load_dwordx4 v[96:99], v4, s[36:39], s80 offen offset:2048 sc1
    buffer_load_dwordx4 v[100:103], v5, s[36:39], s80 offen offset:2048 sc1
    buffer_load_dwordx4 v[104:107], v6, s[36:39], s81 offen offset:2048 sc1
    buffer_load_dwordx4 v[108:111], v7, s[36:39], s81 offen offset:2048 sc1
    s_waitcnt vmcnt(33)
    v_mfma_f32_32x32x16_bf16 v[16:31], v[112:115], v[120:123], v[16:31]
    v_mfma_f32_32x32x16_bf16 v[32:47], v[112:115], v[124:127], v[32:47]
    v_mfma_f32_32x32x16_bf16 v[48:63], v[116:119], v[120:123], v[48:63]
    v_mfma_f32_32x32x16_bf16 v[64:79], v[116:119], v[124:127], v[64:79]
    buffer_load_dwordx4 v[112:115], v4, s[36:39], s80 offen offset:3072 sc1
    buffer_load_dwordx4 v[116:119], v5, s[36:39], s80 offen offset:3072 sc1
    buffer_load_dwordx4 v[120:123], v6, s[36:39], s81 offen offset:3072 sc1
    buffer_load_dwordx4 v[124:127], v7, s[36:39], s81 offen offset:3072 sc1
    s_waitcnt vmcnt(33)
    v_mfma_f32_32x32x16_bf16 v[16:31], v[128:131], v[136:139], v[16:31]
    v_mfma_f32_32x32x16_bf16 v[32:47], v[128:131], v[140:143], v[32:47]
    v_mfma_f32_32x32x16_bf16 v[48:63], v[132:135], v[136:139], v[48:63]
    v_mfma_f32_32x32x16_bf16 v[64:79], v[132:135], v[140:143], v[64:79]
    s_waitcnt vmcnt(29)
    v_mfma_f32_32x32x16_bf16 v[16:31], v[144:147], v[152:155], v[16:31]
    v_mfma_f32_32x32x16_bf16 v[32:47], v[144:147], v[156:159], v[32:47]
    v_mfma_f32_32x32x16_bf16 v[48:63], v[148:151], v[152:155], v[48:63]
    v_mfma_f32_32x32x16_bf16 v[64:79], v[148:151], v[156:159], v[64:79]
    s_waitcnt vmcnt(8)
    s_mov_b64 exec, 1
    v_mov_b32 v9, 1
    ds_add_u32 v13, v9 offset:208
    s_mov_b64 exec, -1
    v_mfma_f32_32x32x16_bf16 v[16:31], v[80:83], v[88:91], v[16:31]
    v_mfma_f32_32x32x16_bf16 v[32:47], v[80:83], v[92:95], v[32:47]
    v_mfma_f32_32x32x16_bf16 v[48:63], v[84:87], v[88:91], v[48:63]
    v_mfma_f32_32x32x16_bf16 v[64:79], v[84:87], v[92:95], v[64:79]
    s_waitcnt vmcnt(4)
    v_mfma_f32_32x32x16_bf16 v[16:31], v[96:99], v[104:107], v[16:31]
    v_mfma_f32_32x32x16_bf16 v[32:47], v[96:99], v[108:111], v[32:47]
    v_mfma_f32_32x32x16_bf16 v[48:63], v[100:103], v[104:107], v[48:63]
    v_mfma_f32_32x32x16_bf16 v[64:79], v[100:103], v[108:111], v[64:79]
    s_waitcnt vmcnt(0)
    v_mfma_f32_32x32x16_bf16 v[16:31], v[112:115], v[120:123], v[16:31]
    v_mfma_f32_32x32x16_bf16 v[32:47], v[112:115], v[124:127], v[32:47]
    v_mfma_f32_32x32x16_bf16 v[48:63], v[116:119], v[120:123], v[48:63]
    v_mfma_f32_32x32x16_bf16 v[64:79], v[116:119], v[124:127], v[64:79]
    s_setprio 3
    s_mov_b32 s60, s22
    s_and_b32 s61, s23, 0xffff
    s_mov_b32 s62, 0x200000
    s_mov_b32 s63, 0x20000
    s_lshl_b32 s5, s50, 2
    v_add_u32 v14, s5, v13
    ds_read_b32 v160, v14 offset:200
    s_lshl_b32 s5, s43, 13
    s_add_u32 s5, s5, 65536
    v_add_u32 v15, s5, v2
    v_xor_b32 v161, 8192, v15
    v_xor_b32 v12, 16384, v15
    s_lshl_b32 s5, s43, 2
    v_add_u32 v11, s5, v13
    v_xor_b32 v8, 4, v11
    v_xor_b32 v162, 8, v11
    s_sub_u32 s57, s55, 25165824
    s_sub_u32 s5, s54, 12582912
    s_lshr_b32 s5, s5, 9
    s_add_u32 s57, s57, s5
    v_and_b32 v3, 31, v1
    v_lshlrev_b32 v6, 10, v3
    v_lshrrev_b32 v4, 5, v1
    v_lshl_add_u32 v6, v4, 4, v6
    v_lshlrev_b32 v7, 7, v3
    s_lshl_b32 s5, s50, 11
    s_add_u32 s56, s56, s5
    s_lshl_b32 s5, s50, 14
    s_add_u32 s55, s55, s5
    s_mul_i32 s5, s50, 49152
    v_add_u32 v5, s5, v2
    s_mov_b32 s48, 0x1111
    s_mov_b32 s75, 0
    s_mov_b32 s77, 0
    v_sub_f32 v10, 1.0, v10
    s_waitcnt lgkmcnt(0)
    v_readfirstlane_b32 s49, v160
    s_and_b32 s49, s49, s48
    s_bitcmp1_b32 s49, 0
    s_cbranch_scc0 L_oia0
    s_add_u32 s6, s55, 0
    buffer_load_dwordx4 v[80:83], v2, s[36:39], s6 offen offset:0 sc1
    buffer_load_dwordx4 v[84:87], v2, s[36:39], s6 offen offset:1024 sc1
    buffer_load_dwordx4 v[88:91], v2, s[36:39], s6 offen offset:2048 sc1
    buffer_load_dwordx4 v[92:95], v2, s[36:39], s6 offen offset:3072 sc1
L_oia0:
    s_bitcmp1_b32 s49, 4
    s_cbranch_scc0 L_oia1
    s_add_u32 s6, s55, 4096
    buffer_load_dwordx4 v[96:99], v2, s[36:39], s6 offen offset:0 sc1
    buffer_load_dwordx4 v[100:103], v2, s[36:39], s6 offen offset:1024 sc1
    buffer_load_dwordx4 v[104:107], v2, s[36:39], s6 offen offset:2048 sc1
    buffer_load_dwordx4 v[108:111], v2, s[36:39], s6 offen offset:3072 sc1
L_oia1:
    s_bitcmp1_b32 s49, 8
    s_cbranch_scc0 L_oia2
    s_add_u32 s6, s55, 8192
    buffer_load_dwordx4 v[112:115], v2, s[36:39], s6 offen offset:0 sc1
    buffer_load_dwordx4 v[116:119], v2, s[36:39], s6 offen offset:1024 sc1
    buffer_load_dwordx4 v[120:123], v2, s[36:39], s6 offen offset:2048 sc1
    buffer_load_dwordx4 v[124:127], v2, s[36:39], s6 offen offset:3072 sc1
L_oia2:
    s_bitcmp1_b32 s49, 12
    s_cbranch_scc0 L_oia3
    s_add_u32 s6, s55, 12288
    buffer_load_dwordx4 v[128:131], v2, s[36:39], s6 offen offset:0 sc1
    buffer_load_dwordx4 v[132:135], v2, s[36:39], s6 offen offset:1024 sc1
    buffer_load_dwordx4 v[136:139], v2, s[36:39], s6 offen offset:2048 sc1
    buffer_load_dwordx4 v[140:143], v2, s[36:39], s6 offen offset:3072 sc1
L_oia3:
L_lw_20020:
    ds_read_b32 v9, v13 offset:212
    s_waitcnt lgkmcnt(0)
    v_readfirstlane_b32 s5, v9
    s_cmp_eq_u32 s5, 8
    s_cbranch_scc1 L_lwd_20021
    s_sleep 2
    s_add_u32 s83, s83, 1
    s_cmp_lt_u32 s83, 200000
    s_cbranch_scc1 L_lw_20020
    s_endpgm
L_lwd_20021:
    ds_write_b128 v161, v[32:35] offset:0
    ds_write_b128 v161, v[36:39] offset:1024
    ds_write_b128 v161, v[40:43] offset:2048
    ds_write_b128 v161, v[44:47] offset:3072
    ds_write_b128 v161, v[64:67] offset:4096
    ds_write_b128 v161, v[68:71] offset:5120
    ds_write_b128 v161, v[72:75] offset:6144
    ds_write_b128 v161, v[76:79] offset:7168
    v_mov_b32 v9, 1
    ds_write_b32 v8, v9 offset:240
    v_mul_f32 v16, v16, v10
    v_mul_f32 v17, v17, v10
    v_mul_f32 v18, v18, v10
    v_mul_f32 v19, v19, v10
    v_mul_f32 v20, v20, v10
    v_mul_f32 v21, v21, v10
    v_mul_f32 v22, v22, v10
    v_mul_f32 v23, v23, v10
    v_mul_f32 v24, v24, v10
    v_mul_f32 v25, v25, v10
    v_mul_f32 v26, v26, v10
    v_mul_f32 v27, v27, v10
    v_mul_f32 v28, v28, v10
    v_mul_f32 v29, v29, v10
    v_mul_f32 v30, v30, v10
    v_mul_f32 v31, v31, v10
    v_mul_f32 v48, v48, v10
    v_mul_f32 v49, v49, v10
    v_mul_f32 v50, v50, v10
    v_mul_f32 v51, v51, v10
    v_mul_f32 v52, v52, v10
    v_mul_f32 v53, v53, v10
    v_mul_f32 v54, v54, v10
    v_mul_f32 v55, v55, v10
    v_mul_f32 v56, v56, v10
    v_mul_f32 v57, v57, v10
    v_mul_f32 v58, v58, v10
    v_mul_f32 v59, v59, v10
    v_mul_f32 v60, v60, v10
    v_mul_f32 v61, v61, v10
    v_mul_f32 v62, v62, v10
    v_mul_f32 v63, v63, v10
L_lw_20022:
    ds_read_b32 v9, v13 offset:208
    s_waitcnt lgkmcnt(0)
    v_readfirstlane_b32 s5, v9
    s_cmp_eq_u32 s5, 4
    s_cbranch_scc1 L_lwd_20023
    s_sleep 2
    s_add_u32 s83, s83, 1
    s_cmp_lt_u32 s83, 200000
    s_cbranch_scc1 L_lw_20022
    s_endpgm
L_lwd_20023:
    s_mov_b32 s53, -1
    s_mov_b32 s73, 0
L_op:
    ds_read_b32 v3, v14 offset:200
    s_or_b32 s6, s49, s75
    s_waitcnt lgkmcnt(0)
    v_readfirstlane_b32 s59, v3
    s_and_b32 s58, s59, s48
    s_bcnt1_i32_b32 s5, s48
    s_cmp_le_u32 s5, 0
    s_cselect_b32 s58, s48, s58
    s_andn2_b32 s58, s58, s6
    s_cbranch_scc0 L_noiss
    s_bitcmp1_b32 s58, 0
    s_cbranch_scc0 L_oib0
    s_add_u32 s6, s55, 0
    buffer_load_dwordx4 v[80:83], v2, s[36:39], s6 offen offset:0 sc1
    buffer_load_dwordx4 v[84:87], v2, s[36:39], s6 offen offset:1024 sc1
    buffer_load_dwordx4 v[88:91], v2, s[36:39], s6 offen offset:2048 sc1
    buffer_load_dwordx4 v[92:95], v2, s[36:39], s6 offen offset:3072 sc1
L_oib0:
    s_bitcmp1_b32 s58, 4
    s_cbranch_scc0 L_oib1
    s_add_u32 s6, s55, 4096
    buffer_load_dwordx4 v[96:99], v2, s[36:39], s6 offen offset:0 sc1
    buffer_load_dwordx4 v[100:103], v2, s[36:39], s6 offen offset:1024 sc1
    buffer_load_dwordx4 v[104:107], v2, s[36:39], s6 offen offset:2048 sc1
    buffer_load_dwordx4 v[108:111], v2, s[36:39], s6 offen offset:3072 sc1
L_oib1:
    s_bitcmp1_b32 s58, 8
    s_cbranch_scc0 L_oib2
    s_add_u32 s6, s55, 8192
    buffer_load_dwordx4 v[112:115], v2, s[36:39], s6 offen offset:0 sc1
    buffer_load_dwordx4 v[116:119], v2, s[36:39], s6 offen offset:1024 sc1
    buffer_load_dwordx4 v[120:123], v2, s[36:39], s6 offen offset:2048 sc1
    buffer_load_dwordx4 v[124:127], v2, s[36:39], s6 offen offset:3072 sc1
L_oib2:
    s_bitcmp1_b32 s58, 12
    s_cbranch_scc0 L_oib3
    s_add_u32 s6, s55, 12288
    buffer_load_dwordx4 v[128:131], v2, s[36:39], s6 offen offset:0 sc1
    buffer_load_dwordx4 v[132:135], v2, s[36:39], s6 offen offset:1024 sc1
    buffer_load_dwordx4 v[136:139], v2, s[36:39], s6 offen offset:2048 sc1
    buffer_load_dwordx4 v[140:143], v2, s[36:39], s6 offen offset:3072 sc1
L_oib3:
    s_or_b32 s49, s49, s58
L_noiss:
    s_cmp_lg_u32 s75, 0
    s_cbranch_scc1 L_proc
    s_cmp_lg_u32 s77, 0
    s_cbranch_scc1 L_mgd_20025
L_mg_20024:
    ds_read_b32 v3, v11 offset:240
    ds_read_b128 v[144:147], v15 offset:0
    ds_read_b128 v[148:151], v15 offset:1024
    ds_read_b128 v[152:155], v15 offset:2048
    ds_read_b128 v[156:159], v15 offset:3072
    s_waitcnt lgkmcnt(0)
    v_readfirstlane_b32 s77, v3
    s_cmp_lg_u32 s77, 0
    s_cbranch_scc1 L_mgo_20026
    s_branch L_mgd_20025
L_mgo_20026:
    v_fmac_f32 v16, v144, v10
    v_fmac_f32 v17, v145, v10
    v_fmac_f32 v18, v146, v10
    v_fmac_f32 v19, v147, v10
    v_fmac_f32 v20, v148, v10
    v_fmac_f32 v21, v149, v10
    v_fmac_f32 v22, v150, v10
    v_fmac_f32 v23, v151, v10
    v_fmac_f32 v24, v152, v10
    v_fmac_f32 v25, v153, v10
    v_fmac_f32 v26, v154, v10
    v_fmac_f32 v27, v155, v10
    v_fmac_f32 v28, v156, v10
    v_fmac_f32 v29, v157, v10
    v_fmac_f32 v30, v158, v10
    v_fmac_f32 v31, v159, v10
    ds_read_b128 v[144:147], v15 offset:4096
    ds_read_b128 v[148:151], v15 offset:5120
    ds_read_b128 v[152:155], v15 offset:6144
    ds_read_b128 v[156:159], v15 offset:7168
    s_waitcnt lgkmcnt(0)
    v_fmac_f32 v48, v144, v10
    v_fmac_f32 v49, v145, v10
    v_fmac_f32 v50, v146, v10
    v_fmac_f32 v51, v147, v10
    v_fmac_f32 v52, v148, v10
    v_fmac_f32 v53, v149, v10
    v_fmac_f32 v54, v150, v10
    v_fmac_f32 v55, v151, v10
    v_fmac_f32 v56, v152, v10
    v_fmac_f32 v57, v153, v10
    v_fmac_f32 v58, v154, v10
    v_fmac_f32 v59, v155, v10
    v_fmac_f32 v60, v156, v10
    v_fmac_f32 v61, v157, v10
    v_fmac_f32 v62, v158, v10
    v_fmac_f32 v63, v159, v10
L_mgd_20025:
    s_cmp_lg_u32 s49, 0
    s_cbranch_scc1 L_owait
    s_andn2_b32 s5, s59, 0x1111
    s_or_b32 s5, s5, s51
    s_cbranch_scc1 L_oidle
    s_andn2_b32 s5, 0x1111, s59
    s_mul_i32 s5, s5, 15
    s_or_b32 exec_lo, s5, 1
    s_mov_b32 exec_hi, 0
    buffer_load_dword v3, v7, s[36:39], s56 offen sc1
    s_waitcnt vmcnt(0)
    v_cmp_ne_u32 vcc, s82, v3
    s_lshr_b32 s5, vcc_lo, 1
    s_or_b32 s5, s5, vcc_lo
    s_lshr_b32 s6, s5, 2
    s_or_b32 s5, s5, s6
    s_andn2_b32 s5, 0x1111, s5
    v_mov_b32 v4, s5
    s_mov_b64 exec, 1
    ds_or_b32 v14, v4 offset:200
    s_mov_b64 exec, -1
    s_cmp_lg_u32 s5, s59
    s_cbranch_scc1 L_op
    s_sleep 4
L_oidle:
    s_sleep 1
    s_add_u32 s83, s83, 1
    s_cmp_lt_u32 s83, 200000
    s_cbranch_scc1 L_op
    s_endpgm
L_owait:
    s_mov_b32 s75, s49
    s_mov_b32 s49, 0
    s_ff1_i32_b32 s52, s75
    s_cmp_eq_u32 s52, s53
    s_cbranch_scc1 L_ow2
    s_mov_b32 s53, s52
    s_lshl_b32 s5, s53, 10
    v_add_u32 v8, s5, v5
    v_xor_b32 v9, 32768, v8
    ds_read_b128 v[32:35], v8 offset:0
    ds_read_b128 v[36:39], v9 offset:0
    ds_read_b128 v[40:43], v8 offset:1024
    ds_read_b128 v[44:47], v9 offset:1024
    ds_read_b128 v[64:67], v8 offset:2048
    ds_read_b128 v[68:71], v9 offset:2048
    ds_read_b128 v[72:75], v8 offset:3072
    ds_read_b128 v[76:79], v9 offset:3072
L_ow2:
    s_waitcnt vmcnt(0)
L_proc:
    s_ff1_i32_b32 s52, s75
    s_bitset0_b32 s75, s52
    s_cmp_eq_u32 s52, s53
    s_cbranch_scc1 L_pr2
    s_mov_b32 s53, s52
    s_lshl_b32 s5, s53, 10
    v_add_u32 v8, s5, v5
    v_xor_b32 v9, 32768, v8
    ds_read_b128 v[32:35], v8 offset:0
    ds_read_b128 v[36:39], v9 offset:0
    ds_read_b128 v[40:43], v8 offset:1024
    ds_read_b128 v[44:47], v9 offset:1024
    ds_read_b128 v[64:67], v8 offset:2048
    ds_read_b128 v[68:71], v9 offset:2048
    ds_read_b128 v[72:75], v8 offset:3072
    ds_read_b128 v[76:79], v9 offset:3072
L_pr2:
    s_cmp_lg_u32 s75, 0
    s_cselect_b32 s5, s75, s49
    s_ff1_i32_b32 s74, s5
    s_max_i32 s74, s74, 0
    s_or_b32 s6, s75, s49
    s_bitset1_b32 s6, s52
    s_andn2_b32 s76, s48, s6
    s_cmp_eq_u32 s75, 0
    s_cselect_b32 s76, 1, s76
    s_lshl_b32 s5, s74, 10
    v_add_u32 v8, s5, v5
    v_xor_b32 v9, 32768, v8
    s_cmp_lg_u32 s52, 0
    s_cbranch_scc1 L_om0
    v_max3_u32 v4, v80, v81, v82
    v_max3_u32 v4, v4, v83, v84
    v_max3_u32 v4, v4, v85, v86
    v_max3_u32 v4, v4, v87, v88
    v_max3_u32 v4, v4, v89, v90
    v_max3_u32 v4, v4, v91, v92
    v_max3_u32 v4, v4, v93, v94
    v_max_u32 v4, v4, v95
    v_cmp_eq_u32 vcc, -1, v4
    s_cmp_eq_u64 vcc, 0
    s_cbranch_scc0 L_ofail
    s_bitset0_b32 s48, 0
    s_mov_b32 s53, s74
    s_waitcnt lgkmcnt(4)
    v_mfma_f32_32x32x16_bf16 v[48:63], v[36:39], v[80:83], v[48:63]
    v_mfma_f32_32x32x16_bf16 v[16:31], v[32:35], v[80:83], v[16:31]
    v_mfma_f32_32x32x16_bf16 v[48:63], v[44:47], v[84:87], v[48:63]
    v_mfma_f32_32x32x16_bf16 v[16:31], v[40:43], v[84:87], v[16:31]
    ds_read_b128 v[32:35], v8 offset:0
    ds_read_b128 v[36:39], v9 offset:0
    ds_read_b128 v[40:43], v8 offset:1024
    ds_read_b128 v[44:47], v9 offset:1024
    s_waitcnt lgkmcnt(4)
    v_mfma_f32_32x32x16_bf16 v[48:63], v[68:71], v[88:91], v[48:63]
    v_mfma_f32_32x32x16_bf16 v[16:31], v[64:67], v[88:91], v[16:31]
    v_mfma_f32_32x32x16_bf16 v[48:63], v[76:79], v[92:95], v[48:63]
    v_mfma_f32_32x32x16_bf16 v[16:31], v[72:75], v[92:95], v[16:31]
    ds_read_b128 v[64:67], v8 offset:2048
    ds_read_b128 v[68:71], v9 offset:2048
    ds_read_b128 v[72:75], v8 offset:3072
    ds_read_b128 v[76:79], v9 offset:3072
    s_cmp_eq_u32 s76, 0
    s_cbranch_scc1 L_proc
    s_cmp_eq_u32 s48, 0
    s_cbranch_scc0 L_op
    s_branch L_odone
L_om0:
    s_cmp_lg_u32 s52, 4
    s_cbranch_scc1 L_om1
    v_max3_u32 v4, v96, v97, v98
    v_max3_u32 v4, v4, v99, v100
    v_max3_u32 v4, v4, v101, v102
    v_max3_u32 v4, v4, v103, v104
    v_max3_u32 v4, v4, v105, v106
    v_max3_u32 v4, v4, v107, v108
    v_max3_u32 v4, v4, v109, v110
    v_max_u32 v4, v4, v111
    v_cmp_eq_u32 vcc, -1, v4
    s_cmp_eq_u64 vcc, 0
    s_cbranch_scc0 L_ofail
    s_bitset0_b32 s48, 4
    s_mov_b32 s53, s74
    s_waitcnt lgkmcnt(4)
    v_mfma_f32_32x32x16_bf16 v[48:63], v[36:39], v[96:99], v[48:63]
    v_mfma_f32_32x32x16_bf16 v[16:31], v[32:35], v[96:99], v[16:31]
    v_mfma_f32_32x32x16_bf16 v[48:63], v[44:47], v[100:103], v[48:63]
    v_mfma_f32_32x32x16_bf16 v[16:31], v[40:43], v[100:103], v[16:31]
    ds_read_b128 v[32:35], v8 offset:0
    ds_read_b128 v[36:39], v9 offset:0
    ds_read_b128 v[40:43], v8 offset:1024
    ds_read_b128 v[44:47], v9 offset:1024
    s_waitcnt lgkmcnt(4)
    v_mfma_f32_32x32x16_bf16 v[48:63], v[68:71], v[104:107], v[48:63]
    v_mfma_f32_32x32x16_bf16 v[16:31], v[64:67], v[104:107], v[16:31]
    v_mfma_f32_32x32x16_bf16 v[48:63], v[76:79], v[108:111], v[48:63]
    v_mfma_f32_32x32x16_bf16 v[16:31], v[72:75], v[108:111], v[16:31]
    ds_read_b128 v[64:67], v8 offset:2048
    ds_read_b128 v[68:71], v9 offset:2048
    ds_read_b128 v[72:75], v8 offset:3072
    ds_read_b128 v[76:79], v9 offset:3072
    s_cmp_eq_u32 s76, 0
    s_cbranch_scc1 L_proc
    s_cmp_eq_u32 s48, 0
    s_cbranch_scc0 L_op
    s_branch L_odone
L_om1:
    s_cmp_lg_u32 s52, 8
    s_cbranch_scc1 L_om2
    v_max3_u32 v4, v112, v113, v114
    v_max3_u32 v4, v4, v115, v116
    v_max3_u32 v4, v4, v117, v118
    v_max3_u32 v4, v4, v119, v120
    v_max3_u32 v4, v4, v121, v122
    v_max3_u32 v4, v4, v123, v124
    v_max3_u32 v4, v4, v125, v126
    v_max_u32 v4, v4, v127
    v_cmp_eq_u32 vcc, -1, v4
    s_cmp_eq_u64 vcc, 0
    s_cbranch_scc0 L_ofail
    s_bitset0_b32 s48, 8
    s_mov_b32 s53, s74
    s_waitcnt lgkmcnt(4)
    v_mfma_f32_32x32x16_bf16 v[48:63], v[36:39], v[112:115], v[48:63]
    v_mfma_f32_32x32x16_bf16 v[16:31], v[32:35], v[112:115], v[16:31]
    v_mfma_f32_32x32x16_bf16 v[48:63], v[44:47], v[116:119], v[48:63]
    v_mfma_f32_32x32x16_bf16 v[16:31], v[40:43], v[116:119], v[16:31]
    ds_read_b128 v[32:35], v8 offset:0
    ds_read_b128 v[36:39], v9 offset:0
    ds_read_b128 v[40:43], v8 offset:1024
    ds_read_b128 v[44:47], v9 offset:1024
    s_waitcnt lgkmcnt(4)
    v_mfma_f32_32x32x16_bf16 v[48:63], v[68:71], v[120:123], v[48:63]
    v_mfma_f32_32x32x16_bf16 v[16:31], v[64:67], v[120:123], v[16:31]
    v_mfma_f32_32x32x16_bf16 v[48:63], v[76:79], v[124:127], v[48:63]
    v_mfma_f32_32x32x16_bf16 v[16:31], v[72:75], v[124:127], v[16:31]
    ds_read_b128 v[64:67], v8 offset:2048
    ds_read_b128 v[68:71], v9 offset:2048
    ds_read_b128 v[72:75], v8 offset:3072
    ds_read_b128 v[76:79], v9 offset:3072
    s_cmp_eq_u32 s76, 0
    s_cbranch_scc1 L_proc
    s_cmp_eq_u32 s48, 0
    s_cbranch_scc0 L_op
    s_branch L_odone
L_om2:
    v_max3_u32 v4, v128, v129, v130
    v_max3_u32 v4, v4, v131, v132
    v_max3_u32 v4, v4, v133, v134
    v_max3_u32 v4, v4, v135, v136
    v_max3_u32 v4, v4, v137, v138
    v_max3_u32 v4, v4, v139, v140
    v_max3_u32 v4, v4, v141, v142
    v_max_u32 v4, v4, v143
    v_cmp_eq_u32 vcc, -1, v4
    s_cmp_eq_u64 vcc, 0
    s_cbranch_scc0 L_ofail
    s_bitset0_b32 s48, 12
    s_mov_b32 s53, s74
    s_waitcnt lgkmcnt(4)
    v_mfma_f32_32x32x16_bf16 v[48:63], v[36:39], v[128:131], v[48:63]
    v_mfma_f32_32x32x16_bf16 v[16:31], v[32:35], v[128:131], v[16:31]
    v_mfma_f32_32x32x16_bf16 v[48:63], v[44:47], v[132:135], v[48:63]
    v_mfma_f32_32x32x16_bf16 v[16:31], v[40:43], v[132:135], v[16:31]
    ds_read_b128 v[32:35], v8 offset:0
    ds_read_b128 v[36:39], v9 offset:0
    ds_read_b128 v[40:43], v8 offset:1024
    ds_read_b128 v[44:47], v9 offset:1024
    s_waitcnt lgkmcnt(4)
    v_mfma_f32_32x32x16_bf16 v[48:63], v[68:71], v[136:139], v[48:63]
    v_mfma_f32_32x32x16_bf16 v[16:31], v[64:67], v[136:139], v[16:31]
    v_mfma_f32_32x32x16_bf16 v[48:63], v[76:79], v[140:143], v[48:63]
    v_mfma_f32_32x32x16_bf16 v[16:31], v[72:75], v[140:143], v[16:31]
    ds_read_b128 v[64:67], v8 offset:2048
    ds_read_b128 v[68:71], v9 offset:2048
    ds_read_b128 v[72:75], v8 offset:3072
    ds_read_b128 v[76:79], v9 offset:3072
    s_cmp_eq_u32 s76, 0
    s_cbranch_scc1 L_proc
    s_cmp_eq_u32 s48, 0
    s_cbranch_scc0 L_op
    s_branch L_odone
L_ofail:
    s_sleep 1
    s_add_u32 s83, s83, 1
    s_cmp_lt_u32 s83, 200000
    s_cbranch_scc1 L_op
    s_endpgm
L_odone:
    s_nop 7
    s_cmp_lg_u32 s77, 0
    s_cbranch_scc1 L_mgd_20028
L_mg_20027:
    ds_read_b32 v3, v11 offset:240
    ds_read_b128 v[144:147], v15 offset:0
    ds_read_b128 v[148:151], v15 offset:1024
    ds_read_b128 v[152:155], v15 offset:2048
    ds_read_b128 v[156:159], v15 offset:3072
    s_waitcnt lgkmcnt(0)
    v_readfirstlane_b32 s77, v3
    s_cmp_lg_u32 s77, 0
    s_cbranch_scc1 L_mgo_20029
    s_sleep 1
    s_add_u32 s83, s83, 1
    s_cmp_lt_u32 s83, 200000
    s_cbranch_scc1 L_mg_20027
    s_endpgm
L_mgo_20029:
    v_fmac_f32 v16, v144, v10
    v_fmac_f32 v17, v145, v10
    v_fmac_f32 v18, v146, v10
    v_fmac_f32 v19, v147, v10
    v_fmac_f32 v20, v148, v10
    v_fmac_f32 v21, v149, v10
    v_fmac_f32 v22, v150, v10
    v_fmac_f32 v23, v151, v10
    v_fmac_f32 v24, v152, v10
    v_fmac_f32 v25, v153, v10
    v_fmac_f32 v26, v154, v10
    v_fmac_f32 v27, v155, v10
    v_fmac_f32 v28, v156, v10
    v_fmac_f32 v29, v157, v10
    v_fmac_f32 v30, v158, v10
    v_fmac_f32 v31, v159, v10
    ds_read_b128 v[144:147], v15 offset:4096
    ds_read_b128 v[148:151], v15 offset:5120
    ds_read_b128 v[152:155], v15 offset:6144
    ds_read_b128 v[156:159], v15 offset:7168
    s_waitcnt lgkmcnt(0)
    v_fmac_f32 v48, v144, v10
    v_fmac_f32 v49, v145, v10
    v_fmac_f32 v50, v146, v10
    v_fmac_f32 v51, v147, v10
    v_fmac_f32 v52, v148, v10
    v_fmac_f32 v53, v149, v10
    v_fmac_f32 v54, v150, v10
    v_fmac_f32 v55, v151, v10
    v_fmac_f32 v56, v152, v10
    v_fmac_f32 v57, v153, v10
    v_fmac_f32 v58, v154, v10
    v_fmac_f32 v59, v155, v10
    v_fmac_f32 v60, v156, v10
    v_fmac_f32 v61, v157, v10
    v_fmac_f32 v62, v158, v10
    v_fmac_f32 v63, v159, v10
L_mgd_20028:
    ds_write_b128 v15, v[48:51] offset:0
    ds_write_b128 v15, v[52:55] offset:1024
    ds_write_b128 v15, v[56:59] offset:2048
    ds_write_b128 v15, v[60:63] offset:3072
    v_mov_b32 v4, 1
    ds_write_b32 v162, v4 offset:224
L_yw:
    ds_read_b32 v3, v11 offset:224
    ds_read_b128 v[48:51], v12 offset:0
    ds_read_b128 v[52:55], v12 offset:1024
    ds_read_b128 v[56:59], v12 offset:2048
    ds_read_b128 v[60:63], v12 offset:3072
    s_waitcnt lgkmcnt(0)
    v_readfirstlane_b32 s5, v3
    s_cmp_lg_u32 s5, 0
    s_cbranch_scc1 L_ywd
    s_sleep 0
    s_add_u32 s83, s83, 1
    s_cmp_lt_u32 s83, 200000
    s_cbranch_scc1 L_yw
    s_endpgm
L_ywd:
    v_add_f32 v16, v16, v48
    v_add_f32 v17, v17, v49
    v_add_f32 v18, v18, v50
    v_add_f32 v19, v19, v51
    v_add_f32 v20, v20, v52
    v_add_f32 v21, v21, v53
    v_add_f32 v22, v22, v54
    v_add_f32 v23, v23, v55
    v_add_f32 v24, v24, v56
    v_add_f32 v25, v25, v57
    v_add_f32 v26, v26, v58
    v_add_f32 v27, v27, v59
    v_add_f32 v28, v28, v60
    v_add_f32 v29, v29, v61
    v_add_f32 v30, v30, v62
    v_add_f32 v31, v31, v63
    v_cvt_pk_bf16_f32 v80, v16, v24
    v_cvt_pk_bf16_f32 v81, v17, v25
    v_cvt_pk_bf16_f32 v82, v18, v26
    v_cvt_pk_bf16_f32 v83, v19, v27
    v_cvt_pk_bf16_f32 v84, v20, v28
    v_cvt_pk_bf16_f32 v85, v21, v29
    v_cvt_pk_bf16_f32 v86, v22, v30
    v_cvt_pk_bf16_f32 v87, v23, v31
    buffer_store_dwordx4 v[80:83], v6, s[60:63], s57 offen
    buffer_store_dwordx4 v[84:87], v6, s[60:63], s57 offen offset:32
L_end:
    s_endpgm
.section .rodata,"a"
.p2align 6
.amdhsa_kernel gated_mix__mha_block__dense_activation_relu__prompt_kernel
  .amdhsa_next_free_vgpr 168
  .amdhsa_next_free_sgpr 102
  .amdhsa_accum_offset 168
  .amdhsa_group_segment_fixed_size 0
  .amdhsa_kernarg_size 80
  .amdhsa_user_sgpr_count 2
  .amdhsa_user_sgpr_kernarg_segment_ptr 1
  .amdhsa_system_sgpr_workgroup_id_x 1
.end_amdhsa_kernel
```
